```python
import torch

def _softmax(x, axis=-1):
    return torch.softmax(x, dim=axis)
def _gelu(x):
    return torch.nn.functional.gelu(x, approximate="tanh")
def _silu(x):
    return torch.nn.functional.silu(x)
def _sigmoid(x):
    return torch.sigmoid(x)
def _layernorm(x, axis=-1, eps=1e-5):
    m = x.mean(dim=axis, keepdim=True)
    v = x.var(dim=axis, keepdim=True, unbiased=False)
    return (x - m) / torch.sqrt(v + eps)
def _scatter_add(tgt, idx, src, axis=0):
    return tgt.clone().index_add_(axis, idx, src)
def _segment_sum(src, seg, n):
    out = torch.zeros((n,) + src.shape[1:], dtype=src.dtype)
    return out.index_add_(0, seg, src)
def _pad(x, pw):
    flat = tuple(v for pair in reversed(pw) for v in pair)
    return torch.nn.functional.pad(x, flat)

kernel_name = 'standalone__edm_precond__diffusion'

def setup_inputs():

    _w = (lambda a: (lambda t: t.to(torch.bfloat16) if t.is_floating_point() else t)(torch.as_tensor(a)))
    B, C, HW = 2, 512, 64
    return {
        "x": _w((lambda *s: torch.randn(*s, dtype=torch.bfloat16) * 0.4)(B, C, HW, HW)),
        "sigma": _w((lambda _x: torch.exp(torch.as_tensor(_x)))((lambda *s: torch.randn(*s, dtype=torch.bfloat16) * 3.2)(B))),
        "w_in": _w((lambda *s: torch.randn(*s, dtype=torch.bfloat16) * 3.2)(C, C) * (C ** -0.5)),
        "w_emb": _w((lambda *s: torch.randn(*s, dtype=torch.bfloat16) * 3.2)(1, C)),
        "w_out": _w((lambda *s: torch.randn(*s, dtype=torch.bfloat16) * 3.2)(C, C) * (C ** -0.5)),
    }

def reference(x, sigma, w_in, w_emb, w_out):
    B, C, H, W = x.shape
    sigma_data = 0.5
    s = sigma.reshape(B, 1, 1, 1)
    denom = s * s + sigma_data * sigma_data
    c_skip = (sigma_data * sigma_data) / denom
    c_out  = s * sigma_data / torch.sqrt(denom)
    c_in   = 1.0 / torch.sqrt(denom)
    c_noise = 0.25 * torch.log(sigma).reshape(B, 1)
    h = torch.einsum("bchw,cd->bdhw", c_in * x, w_in)
    h = h + (c_noise @ w_emb).reshape(B, C, 1, 1)
    h = _silu(h)
    Fx = torch.einsum("bchw,cd->bdhw", h, w_out)
    return c_skip * x + c_out * Fx
```

```asm
; @launch grid=(256,1,1) block=(512,1,1) lds=155648
.amdgcn_target "amdgcn-amd-amdhsa--gfx950"
.text
.globl standalone__edm_precond__diffusion_kernel
.p2align 12
.p2align 8
.type standalone__edm_precond__diffusion_kernel,@function
standalone__edm_precond__diffusion_kernel:
    s_load_dwordx16 s[4:19], s[0:1], 0
    s_cmp_ge_u32 s2, 0x100
    s_cbranch_scc1 L_exit
    v_lshrrev_b32 v2, 6, v0
    v_and_b32 v1, 63, v0
    v_readfirstlane_b32 s22, v2
    s_lshr_b32 s44, s2, 3
    s_getpc_b64 s[20:21]
L_pc:
    s_lshl_b32 s45, s44, 3
    v_add_lshl_u32 v3, v2, s45, 7
    v_min_u32 v3, L_end-L_pc-4, v3
    global_load_dword v15, v3, s[20:21]
    s_and_b32 s23, s44, 3
    s_lshr_b32 s24, s44, 2
    s_and_b32 s45, s2, 7
    s_lshl3_add_u32 s25, s24, s45
    s_lshr_b32 s44, s25, 5
    s_lshl_b32 s27, s44, 22
    s_and_b32 s45, s25, 31
    s_lshl_b32 s45, s45, 8
    s_add_u32 s27, s27, s45
    s_cmp_lt_u32 s22, 4
    s_cbranch_scc1 L_compute
    v_lshrrev_b32 v4, 4, v1
    v_lshlrev_b32 v6, 1, v2
    v_xor_b32 v6, v6, v1
    v_and_b32 v6, 3, v6
    v_lshlrev_b32 v6, 4, v6
    v_bfe_u32 v5, v0, 2, 2
    v_and_b32 v2, 3, v2
    v_lshl_add_u32 v5, v2, 2, v5
    v_lshl_add_u32 v7, v4, 6, v6
    v_lshl_add_u32 v2, v5, 13, v7
    v_add_u32 v2, s27, v2
    s_lshl_b32 s44, s23, 8
    v_lshl_add_u32 v5, v5, 10, s44
    v_add_u32 v3, v5, v7
    s_and_b32 s41, s22, 3
    s_lshl_b32 s41, s41, 10
    s_mov_b32 s40, 0
    s_add_u32 s46, s23, s24
    s_mov_b32 s48, 0x76543210
    s_mov_b32 s49, 0xfedcba98
    s_lshl_b32 s45, s24, 16
    s_add_u32 s44, s44, s45
    s_lshl_b32 s45, s41, 4
    s_add_u32 s44, s44, s45
    s_lshl_b32 s45, s2, 11
    s_and_b32 s45, s45, 0x3800
    s_add_u32 s44, s44, s45
    v_bfe_u32 v13, v1, 1, 1
    v_lshl_add_u32 v14, v13, 10, s44
    v_and_b32 v13, 1, v1
    v_lshl_add_u32 v14, v13, 7, v14
    s_mov_b32 s47, 0x3c00
    v_and_b32 v8, 7, v1
    v_lshlrev_b32 v8, 2, v8
    v_add_u32 v8, 133120, v8
    v_mov_b32 v9, 0
    ds_write_b32 v8, v9
    v_and_b32 v11, 3, v1
    s_lshl_b32 s44, s25, 9
    v_max_u32 v12, 1, v11
    v_add_u32 v12, s23, v12
    v_and_b32 v12, 3, v12
    v_lshl_add_u32 v12, v12, 4, s44
    s_mov_b32 s30, 0x800000
    s_mov_b32 s31, 0x20000
    s_mov_b32 s34, 0x80000
    s_mov_b32 s35, 0x20000
    s_waitcnt lgkmcnt(0)
    s_mov_b64 s[28:29], s[4:5]
    s_mov_b64 s[32:33], s[8:9]
L_ld1:
    s_add_u32 s44, s48, s46
    s_and_b32 s44, s44, 3
    s_bfe_u32 s45, s48, 0x20002
    s_lshr_b64 s[48:49], s[48:49], 4
    s_lshl2_add_u32 s44, s44, s45
    s_mov_b32 m0, s41
    s_lshl_b32 s42, s44, 18
    buffer_load_dwordx4 v2, s[28:31], s42 offen lds
    s_add_u32 m0, s41, 0x1000
    s_lshl_b32 s43, s44, 15
    buffer_load_dwordx4 v3, s[32:35], s43 offen lds
    s_add_u32 m0, s41, 0x2000
    s_add_u32 s42, s42, 0x20000
    buffer_load_dwordx4 v2, s[28:31], s42 offen lds
    s_add_u32 m0, s41, 0x3000
    s_add_u32 s43, s43, 0x4000
    buffer_load_dwordx4 v3, s[32:35], s43 offen lds
    s_cmp_lg_u32 s40, 4
    s_cbranch_scc1 L_notouch
    global_load_dword v10, v14, s[12:13]
    v_add_u32 v13, 2048, v14
    v_bfi_b32 v14, s47, v13, v14
L_notouch:
    s_add_u32 s41, s41, 0x4000
    s_and_b32 s41, s41, 0x1ffff
    s_add_u32 s40, s40, 1
    s_cmp_lt_u32 s40, 4
    s_cbranch_scc1 L_ld1
    s_waitcnt vmcnt(12)
    s_barrier
    s_cmp_lt_u32 s40, 16
    s_cbranch_scc1 L_ld1
    s_mov_b64 s[32:33], s[12:13]
    s_lshl_b32 s43, s23, 17
L_ld2:
    s_mov_b32 m0, s41
    s_add_u32 s40, s40, 1
    buffer_load_dwordx4 v3, s[32:35], s43 offen lds
    s_add_u32 m0, s41, 0x1000
    s_add_u32 s44, s43, 0x4000
    buffer_load_dwordx4 v3, s[32:35], s44 offen lds
    s_add_u32 m0, s41, 0x2000
    s_add_u32 s44, s43, 0x8000
    buffer_load_dwordx4 v3, s[32:35], s44 offen lds
    s_add_u32 m0, s41, 0x3000
    s_add_u32 s44, s43, 0xc000
    buffer_load_dwordx4 v3, s[32:35], s44 offen lds
    s_add_u32 s41, s41, 0x4000
    s_add_u32 s43, s43, 0x10000
    s_and_b32 s43, s43, 0x7ffff
    s_cmp_lt_u32 s40, 21
    s_cbranch_scc0 L_ld3
    s_waitcnt vmcnt(12)
    s_barrier
    s_branch L_ld2
L_ld3:
    s_waitcnt vmcnt(4)
    s_cmp_lg_u32 s40, 22
    s_cbranch_scc1 L_ld4
    global_load_dword v16, v12, s[18:19] offset:256 sc1
    s_barrier
L_ld4:
    s_cmp_lt_u32 s40, 24
    s_cbranch_scc1 L_ld2
    s_lshl_b32 s44, s22, 2
    s_add_u32 s44, s44, 133120
    v_mov_b32 v8, s44
    v_mov_b32 v9, 1
    v_mov_b32 v13, 133120
    s_mov_b32 s62, 0
    s_waitcnt vmcnt(0)
    ds_write_b32 v8, v9
    s_cmp_lg_u32 s22, 4
    s_cbranch_scc1 L_fin
L_poll:
    global_load_dwordx4 v[16:19], v12, s[18:19] offset:256 sc1
    s_add_u32 s62, s62, 1
    s_waitcnt vmcnt(0)
    v_min3_u32 v16, v16, v17, v18
    v_min_u32 v16, v16, v19
    s_nop 1
    v_min_u32_dpp v16, v16, v16 quad_perm:[1,0,3,2] row_mask:0xf bank_mask:0xf
    s_nop 1
    v_min_u32_dpp v16, v16, v16 quad_perm:[2,3,0,1] row_mask:0xf bank_mask:0xf
    ds_write_b32 v13, v16
    v_readfirstlane_b32 s44, v16
    s_cmp_ge_u32 s62, 0x1000000
    s_cselect_b32 s44, 5, s44
    s_cmp_lt_u32 s44, 4
    s_cbranch_scc1 L_poll
L_fin:
L_exit:
    s_endpgm
L_compute:
    s_lshl_b32 s44, s23, 8
    v_lshl_add_u32 v86, v1, 2, s44
    s_lshr_b32 s44, s27, 21
    v_mov_b32 v87, s44
    v_lshlrev_b32 v88, 24, v0
    v_mov_b32 v92, 0
    v_mov_b32 v93, 0
    v_mov_b32 v94, 0
    v_mov_b32 v95, 0
    s_lshl_b32 s20, s25, 9
    s_lshl4_add_u32 s46, s23, s20
    s_mov_b32 s30, 0x808000
    s_mov_b32 s31, 0x20000
    s_getreg_b32 s65, hwreg(HW_REG_XCC_ID, 0, 4)
    s_waitcnt lgkmcnt(0)
    global_load_ushort v89, v87, s[6:7]
    global_load_dword v90, v86, s[10:11]
    s_mov_b64 s[28:29], s[18:19]
    buffer_load_dword v91, v92, s[28:31], s20 offen sc1
    buffer_store_dwordx4 v[92:95], v88, s[28:31], s46 offen offset:256 sc1
    v_lshrrev_b32 v84, 4, v1
    v_bfe_u32 v85, v1, 2, 2
    v_lshlrev_b32 v85, 6, v85
    v_lshl_add_u32 v2, v84, 10, v85
    v_and_b32 v85, 1, v84
    v_lshl_add_u32 v2, v85, 5, v2
    v_and_b32 v85, 3, v1
    v_lshl_add_u32 v8, v85, 3, v2
    s_lshl_b32 s44, s22, 8
    v_add_u32 v4, s44, v8
    s_and_b32 s47, s22, 1
    s_lshl_b32 s45, s47, 9
    v_add_u32 v2, s45, v8
    v_xor_b32 v3, 32, v2
    v_xor_b32 v5, 32, v4
    v_xor_b32 v6, 0x100, v4
    v_xor_b32 v7, 0x100, v5
    s_lshl_b32 s45, s47, 14
    v_add_u32 v8, s45, v8
    s_mov_b64 s[32:33], s[14:15]
    s_mov_b32 s34, 0x800000
    s_mov_b32 s35, 0x20000
    v_lshrrev_b32 v99, 2, v1
    v_and_b32 v98, 15, v1
    s_lshl2_add_u32 s46, s22, s46
    v_lshl_add_u32 v12, v1, 24, s46
    v_lshlrev_b32 v112, 3, v85
    s_mov_b32 s66, 0
    s_lshl_b32 s44, s22, 9
    s_add_u32 s44, s44, 131072
    v_lshl_add_u32 v101, v1, 3, s44
    s_lshl_b32 s45, s47, 8
    s_add_u32 s44, s44, s45
    v_lshl_add_u32 v102, v84, 4, s44
    s_mul_i32 s44, s22, 5120
    s_add_u32 s44, s44, 135168
    v_lshlrev_b32 v10, 4, v1
    v_add_u32 v13, s44, v10
    v_mul_u32_u24 v16, 80, v98
    v_lshl_add_u32 v16, v84, 3, v16
    v_add_u32 v16, s44, v16
    v_mul_u32_u24 v17, 80, v99
    v_lshl_add_u32 v17, v85, 4, v17
    v_add_u32 v17, s44, v17
    s_xor_b32 s44, s22, 1
    s_mul_i32 s44, s44, 5120
    s_add_u32 s44, s44, 135168
    v_add_u32 v11, s44, v10
    s_lshl_b32 s44, s23, 20
    s_add_u32 s44, s44, s27
    s_lshl_b32 s45, s22, 6
    s_add_u32 s44, s44, s45
    v_lshl_add_u32 v18, v99, 13, s44
    v_lshl_add_u32 v18, v85, 4, v18
    v_mov_b32 v19, 133120
    s_sub_u32 s26, 0, s24
    s_and_b32 s26, s26, 3
    s_mov_b32 s40, 0
    s_lshl_b32 s44, s26, 14
    v_add_u32 v9, s44, v4
    v_add_u32 v14, s44, v5
    v_lshrrev_b32 v96, 4, v1
    v_and_b32 v10, 15, v1
    v_lshlrev_b32 v10, 4, v10
    v_lshl_add_u32 v10, v96, 11, v10
    s_lshl4_add_u32 s45, s25, s22
    s_lshl_b32 s45, s45, 13
    s_add_u32 s45, s45, 0x8000
    s_add_u32 s47, s23, 0
    s_and_b32 s47, s47, 3
    s_lshl_b32 s47, s47, 15
    s_add_u32 s55, s47, s45
    s_xor_b32 s54, s55, 0x0
    s_add_u32 s54, s54, 0x400
    s_add_u32 s47, s23, 1
    s_and_b32 s47, s47, 3
    s_lshl_b32 s47, s47, 15
    s_add_u32 s57, s47, s45
    s_xor_b32 s56, s57, 0x2000
    s_add_u32 s56, s56, 0x400
    s_add_u32 s47, s23, 2
    s_and_b32 s47, s47, 3
    s_lshl_b32 s47, s47, 15
    s_add_u32 s59, s47, s45
    s_xor_b32 s58, s59, 0x2000
    s_add_u32 s58, s58, 0x400
    s_add_u32 s47, s23, 3
    s_and_b32 s47, s47, 3
    s_lshl_b32 s47, s47, 15
    s_add_u32 s61, s47, s45
    s_xor_b32 s60, s61, 0x2000
    s_add_u32 s60, s60, 0x400
    s_waitcnt vmcnt(2)
    v_lshlrev_b32 v89, 16, v89
    v_mul_f32 v104, v89, v89
    v_cvt_pk_bf16_f32 v104, v104, v104
    v_lshlrev_b32 v104, 16, v104
    v_add_f32 v104, 0x3e800000, v104
    v_cvt_pk_bf16_f32 v104, v104, v104
    v_lshlrev_b32 v104, 16, v104
    v_rcp_f32 v106, v104
    v_sqrt_f32 v104, v104
    v_cvt_pk_bf16_f32 v106, v106, v106
    v_lshlrev_b32 v106, 16, v106
    v_cvt_pk_bf16_f32 v104, v104, v104
    v_lshlrev_b32 v104, 16, v104
    v_mul_f32 v106, 0x3e800000, v106
    v_rcp_f32 v104, v104
    v_lshrrev_b32 v106, 16, v106
    v_mul_f32 v105, 0.5, v89
    v_mul_f32 v105, v105, v104
    v_cvt_pk_bf16_f32 v105, v105, v105
    v_lshlrev_b32 v105, 16, v105
    v_cvt_pk_bf16_f32 v104, v104, v104
    v_lshlrev_b32 v104, 16, v104
    v_log_f32 v107, v89
    v_mul_f32 v104, 0xbfb8aa3b, v104
    v_mul_f32 v107, 0x3f317218, v107
    v_cvt_pk_bf16_f32 v107, v107, v107
    v_lshlrev_b32 v107, 16, v107
    v_max_f32 v105, 0x03800000, v105
    v_mul_f32 v105, 0xbf317218, v105
    v_rcp_f32 v105, v105
    v_mul_f32 v107, 0x3e800000, v107
    v_readfirstlane_b32 s48, v104
    v_readfirstlane_b32 s50, v105
    s_mov_b32 s49, s48
    s_mov_b32 s51, s50
    v_lshlrev_b32 v108, 16, v90
    v_and_b32 v109, 0xffff0000, v90
    v_mul_f32 v108, v107, v108
    v_mul_f32 v109, v107, v109
    v_cvt_pk_bf16_f32 v109, v108, v109
    v_lshlrev_b32 v108, 16, v109
    v_and_b32 v109, 0xffff0000, v109
    v_mul_f32 v108, 0xbfb8aa3b, v108
    v_mul_f32 v109, 0xbfb8aa3b, v109
    ds_write_b64 v101, v[108:109]
    ds_read_b128 v[148:151], v102 offset:0
    ds_read_b128 v[152:155], v102 offset:64
    ds_read_b128 v[156:159], v102 offset:128
    ds_read_b128 v[160:163], v102 offset:192
    v_and_b32 v108, 1, v1
    v_lshlrev_b32 v108, 4, v108
    v_lshlrev_b32 v106, v108, v106
    v_lshrrev_b32 v108, 1, v98
    v_lshlrev_b32 v109, 1, v84
    v_sub_u32 v108, v108, v109
    v_cmp_eq_u32 vcc, 0, v108
    v_mov_b32 v164, 0
    s_nop 0
    v_cndmask_b32 v166, 0, v106, vcc
    v_cmp_eq_u32 vcc, 1, v108
    v_mov_b32 v165, 0
    s_nop 0
    v_cndmask_b32 v167, 0, v106, vcc
    v_mov_b32 v168, 0
    v_mov_b32 v169, 0
    s_barrier
    ds_read_b64_tr_b16 v[172:173], v2 offset:4096
    ds_read_b64_tr_b16 v[174:175], v2 offset:12288
    ds_read_b64_tr_b16 v[176:177], v4 offset:0
    ds_read_b64_tr_b16 v[178:179], v4 offset:8192
    ds_read_b64_tr_b16 v[180:181], v5 offset:0
    ds_read_b64_tr_b16 v[182:183], v5 offset:8192
    ds_read_b64_tr_b16 v[184:185], v3 offset:4096
    ds_read_b64_tr_b16 v[186:187], v3 offset:12288
    ds_read_b64_tr_b16 v[188:189], v6 offset:0
    ds_read_b64_tr_b16 v[190:191], v6 offset:8192
    ds_read_b64_tr_b16 v[192:193], v2 offset:4352
    ds_read_b64_tr_b16 v[194:195], v2 offset:12544
    s_waitcnt lgkmcnt(8)
    v_mfma_f32_16x16x32_bf16 v[20:23], v[172:175], v[176:179], 0
    ds_read_b64_tr_b16 v[196:197], v7 offset:0
    s_waitcnt lgkmcnt(7)
    v_mfma_f32_16x16x32_bf16 v[36:39], v[172:175], v[180:183], 0
    ds_read_b64_tr_b16 v[198:199], v7 offset:8192
    s_waitcnt lgkmcnt(6)
    v_mfma_f32_16x16x32_bf16 v[40:43], v[184:187], v[180:183], 0
    ds_read_b64_tr_b16 v[200:201], v3 offset:4352
    v_mfma_f32_16x16x32_bf16 v[24:27], v[184:187], v[176:179], 0
    ds_read_b64_tr_b16 v[202:203], v3 offset:12544
    s_waitcnt lgkmcnt(6)
    v_mfma_f32_16x16x32_bf16 v[56:59], v[184:187], v[188:191], 0
    s_barrier
    ds_read_b64_tr_b16 v[204:205], v2 offset:20480
    v_mfma_f32_16x16x32_bf16 v[52:55], v[172:175], v[188:191], 0
    ds_read_b64_tr_b16 v[206:207], v2 offset:28672
    s_waitcnt lgkmcnt(6)
    v_mfma_f32_16x16x32_bf16 v[60:63], v[192:195], v[188:191], 0
    ds_read_b64_tr_b16 v[208:209], v4 offset:16384
    v_mfma_f32_16x16x32_bf16 v[44:47], v[192:195], v[180:183], 0
    ds_read_b64_tr_b16 v[210:211], v4 offset:24576
    v_mfma_f32_16x16x32_bf16 v[28:31], v[192:195], v[176:179], 0
    ds_read_b64_tr_b16 v[212:213], v5 offset:16384
    s_waitcnt lgkmcnt(7)
    v_mfma_f32_16x16x32_bf16 v[76:79], v[192:195], v[196:199], 0
    ds_read_b64_tr_b16 v[214:215], v5 offset:24576
    v_mfma_f32_16x16x32_bf16 v[72:75], v[184:187], v[196:199], 0
    ds_read_b64_tr_b16 v[216:217], v3 offset:20480
    v_mfma_f32_16x16x32_bf16 v[68:71], v[172:175], v[196:199], 0
    ds_read_b64_tr_b16 v[218:219], v3 offset:28672
    s_waitcnt lgkmcnt(8)
    v_mfma_f32_16x16x32_bf16 v[80:83], v[200:203], v[196:199], 0
    ds_read_b64_tr_b16 v[220:221], v6 offset:16384
    v_mfma_f32_16x16x32_bf16 v[64:67], v[200:203], v[188:191], 0
    ds_read_b64_tr_b16 v[222:223], v6 offset:24576
    v_mfma_f32_16x16x32_bf16 v[48:51], v[200:203], v[180:183], 0
    ds_read_b64_tr_b16 v[224:225], v2 offset:20736
    v_mfma_f32_16x16x32_bf16 v[32:35], v[200:203], v[176:179], 0
    ds_read_b64_tr_b16 v[226:227], v2 offset:28928
    s_waitcnt lgkmcnt(8)
    v_mfma_f32_16x16x32_bf16 v[20:23], v[204:207], v[208:211], v[20:23]
    ds_read_b64_tr_b16 v[228:229], v7 offset:16384
    s_waitcnt lgkmcnt(7)
    v_mfma_f32_16x16x32_bf16 v[36:39], v[204:207], v[212:215], v[36:39]
    ds_read_b64_tr_b16 v[230:231], v7 offset:24576
    s_waitcnt lgkmcnt(6)
    v_mfma_f32_16x16x32_bf16 v[40:43], v[216:219], v[212:215], v[40:43]
    ds_read_b64_tr_b16 v[232:233], v3 offset:20736
    v_mfma_f32_16x16x32_bf16 v[24:27], v[216:219], v[208:211], v[24:27]
    ds_read_b64_tr_b16 v[234:235], v3 offset:28928
    s_waitcnt lgkmcnt(6)
    v_mfma_f32_16x16x32_bf16 v[56:59], v[216:219], v[220:223], v[56:59]
    s_barrier
    ds_read_b64_tr_b16 v[236:237], v2 offset:36864
    s_waitcnt vmcnt(0)
    v_mfma_f32_16x16x32_bf16 v[52:55], v[204:207], v[220:223], v[52:55]
    ds_read_b64_tr_b16 v[238:239], v2 offset:45056
    s_waitcnt lgkmcnt(6)
    v_mfma_f32_16x16x32_bf16 v[60:63], v[224:227], v[220:223], v[60:63]
    ds_read_b64_tr_b16 v[240:241], v4 offset:32768
    v_readfirstlane_b32 s47, v91
    v_mfma_f32_16x16x32_bf16 v[44:47], v[224:227], v[212:215], v[44:47]
    ds_read_b64_tr_b16 v[242:243], v4 offset:40960
    s_mul_i32 s63, s47, 0x9e3779b1
    v_mfma_f32_16x16x32_bf16 v[28:31], v[224:227], v[208:211], v[28:31]
    ds_read_b64_tr_b16 v[244:245], v5 offset:32768
    s_waitcnt lgkmcnt(7)
    v_mfma_f32_16x16x32_bf16 v[76:79], v[224:227], v[228:231], v[76:79]
    ds_read_b64_tr_b16 v[246:247], v5 offset:40960
    s_add_u32 s63, s63, 0x7f4a7c15
    v_mfma_f32_16x16x32_bf16 v[72:75], v[216:219], v[228:231], v[72:75]
    ds_read_b64_tr_b16 v[248:249], v3 offset:36864
    s_mul_i32 s64, s47, 0x85ebca77
    v_mfma_f32_16x16x32_bf16 v[68:71], v[204:207], v[228:231], v[68:71]
    ds_read_b64_tr_b16 v[250:251], v3 offset:45056
    s_waitcnt lgkmcnt(8)
    v_mfma_f32_16x16x32_bf16 v[80:83], v[232:235], v[228:231], v[80:83]
    ds_read_b64_tr_b16 v[252:253], v6 offset:32768
    s_add_u32 s64, s64, 0xc2b2ae3d
    v_mfma_f32_16x16x32_bf16 v[64:67], v[232:235], v[220:223], v[64:67]
    ds_read_b64_tr_b16 v[254:255], v6 offset:40960
    s_add_u32 s63, s63, s65
    v_mfma_f32_16x16x32_bf16 v[48:51], v[232:235], v[212:215], v[48:51]
    ds_read_b64_tr_b16 v[184:185], v2 offset:37120
    s_add_u32 s64, s64, s65
    v_mfma_f32_16x16x32_bf16 v[32:35], v[232:235], v[208:211], v[32:35]
    ds_read_b64_tr_b16 v[186:187], v2 offset:45312
    s_waitcnt lgkmcnt(8)
    v_mfma_f32_16x16x32_bf16 v[20:23], v[236:239], v[240:243], v[20:23]
    ds_read_b64_tr_b16 v[192:193], v7 offset:32768
    s_waitcnt lgkmcnt(7)
    v_mfma_f32_16x16x32_bf16 v[36:39], v[236:239], v[244:247], v[36:39]
    ds_read_b64_tr_b16 v[194:195], v7 offset:40960
    s_waitcnt lgkmcnt(6)
    v_mfma_f32_16x16x32_bf16 v[40:43], v[248:251], v[244:247], v[40:43]
    ds_read_b64_tr_b16 v[172:173], v3 offset:37120
    v_mov_b32 v96, s63
    v_mfma_f32_16x16x32_bf16 v[24:27], v[248:251], v[240:243], v[24:27]
    ds_read_b64_tr_b16 v[174:175], v3 offset:45312
    s_waitcnt lgkmcnt(6)
    v_mfma_f32_16x16x32_bf16 v[56:59], v[248:251], v[252:255], v[56:59]
    s_barrier
    ds_read_b64_tr_b16 v[116:117], v9 offset:0
    ds_read_b64_tr_b16 v[118:119], v9 offset:8192
    ds_read_b64_tr_b16 v[120:121], v14 offset:0
    ds_read_b64_tr_b16 v[122:123], v14 offset:8192
    ds_read_b64_tr_b16 v[196:197], v2 offset:53248
    v_mov_b32 v97, s64
    v_mfma_f32_16x16x32_bf16 v[52:55], v[236:239], v[252:255], v[52:55]
    ds_read_b64_tr_b16 v[198:199], v2 offset:61440
    s_waitcnt lgkmcnt(10)
    v_mfma_f32_16x16x32_bf16 v[60:63], v[184:187], v[252:255], v[60:63]
    ds_read_b64_tr_b16 v[180:181], v4 offset:49152
    s_lshl3_add_u32 s44, s23, s20
    v_mfma_f32_16x16x32_bf16 v[44:47], v[184:187], v[244:247], v[44:47]
    ds_read_b64_tr_b16 v[182:183], v4 offset:57344
    buffer_store_dwordx2 v[96:97], v88, s[28:31], s44 offen offset:128 sc1
    v_mfma_f32_16x16x32_bf16 v[28:31], v[184:187], v[240:243], v[28:31]
    ds_read_b64_tr_b16 v[188:189], v5 offset:49152
    s_waitcnt lgkmcnt(11)
    v_mfma_f32_16x16x32_bf16 v[76:79], v[184:187], v[192:195], v[76:79]
    ds_read_b64_tr_b16 v[190:191], v5 offset:57344
    s_add_u32 s21, s47, 1
    v_mfma_f32_16x16x32_bf16 v[72:75], v[248:251], v[192:195], v[72:75]
    ds_read_b64_tr_b16 v[176:177], v3 offset:53248
    v_mfma_f32_16x16x32_bf16 v[68:71], v[236:239], v[192:195], v[68:71]
    ds_read_b64_tr_b16 v[178:179], v3 offset:61440
    s_waitcnt lgkmcnt(12)
    v_mfma_f32_16x16x32_bf16 v[80:83], v[172:175], v[192:195], v[80:83]
    ds_read_b64_tr_b16 v[200:201], v6 offset:49152
    v_mfma_f32_16x16x32_bf16 v[64:67], v[172:175], v[252:255], v[64:67]
    ds_read_b64_tr_b16 v[202:203], v6 offset:57344
    v_mfma_f32_16x16x32_bf16 v[48:51], v[172:175], v[244:247], v[48:51]
    ds_read_b64_tr_b16 v[216:217], v2 offset:53504
    v_mfma_f32_16x16x32_bf16 v[32:35], v[172:175], v[240:243], v[32:35]
    ds_read_b64_tr_b16 v[218:219], v2 offset:61696
    s_waitcnt lgkmcnt(8)
    v_mfma_f32_16x16x32_bf16 v[20:23], v[196:199], v[180:183], v[20:23]
    ds_read_b64_tr_b16 v[224:225], v7 offset:49152
    s_waitcnt lgkmcnt(7)
    v_mfma_f32_16x16x32_bf16 v[36:39], v[196:199], v[188:191], v[36:39]
    ds_read_b64_tr_b16 v[226:227], v7 offset:57344
    s_waitcnt lgkmcnt(6)
    v_mfma_f32_16x16x32_bf16 v[40:43], v[176:179], v[188:191], v[40:43]
    ds_read_b64_tr_b16 v[204:205], v3 offset:53504
    v_mfma_f32_16x16x32_bf16 v[24:27], v[176:179], v[180:183], v[24:27]
    ds_read_b64_tr_b16 v[206:207], v3 offset:61696
    s_waitcnt lgkmcnt(6)
    v_mfma_f32_16x16x32_bf16 v[56:59], v[176:179], v[200:203], v[56:59]
    v_xor_b32 v2, 0x10000, v2
    v_xor_b32 v3, 0x10000, v3
    v_xor_b32 v4, 0x10000, v4
    v_xor_b32 v5, 0x10000, v5
    v_xor_b32 v6, 0x10000, v6
    v_xor_b32 v7, 0x10000, v7
    v_xor_b32 v9, 0x10000, v9
    v_xor_b32 v14, 0x10000, v14
    s_barrier
    ds_read_b64_tr_b16 v[228:229], v2 offset:4096
    v_mfma_f32_16x16x32_bf16 v[52:55], v[196:199], v[200:203], v[52:55]
    ds_read_b64_tr_b16 v[230:231], v2 offset:12288
    s_waitcnt lgkmcnt(6)
    v_mfma_f32_16x16x32_bf16 v[60:63], v[216:219], v[200:203], v[60:63]
    ds_read_b64_tr_b16 v[212:213], v4 offset:0
    v_mfma_f32_16x16x32_bf16 v[44:47], v[216:219], v[188:191], v[44:47]
    ds_read_b64_tr_b16 v[214:215], v4 offset:8192
    v_mfma_f32_16x16x32_bf16 v[28:31], v[216:219], v[180:183], v[28:31]
    ds_read_b64_tr_b16 v[220:221], v5 offset:0
    s_waitcnt lgkmcnt(7)
    v_mfma_f32_16x16x32_bf16 v[76:79], v[216:219], v[224:227], v[76:79]
    ds_read_b64_tr_b16 v[222:223], v5 offset:8192
    v_mfma_f32_16x16x32_bf16 v[72:75], v[176:179], v[224:227], v[72:75]
    ds_read_b64_tr_b16 v[208:209], v3 offset:4096
    v_mfma_f32_16x16x32_bf16 v[68:71], v[196:199], v[224:227], v[68:71]
    ds_read_b64_tr_b16 v[210:211], v3 offset:12288
    s_waitcnt lgkmcnt(8)
    v_mfma_f32_16x16x32_bf16 v[80:83], v[204:207], v[224:227], v[80:83]
    ds_read_b64_tr_b16 v[232:233], v6 offset:0
    v_mfma_f32_16x16x32_bf16 v[64:67], v[204:207], v[200:203], v[64:67]
    ds_read_b64_tr_b16 v[234:235], v6 offset:8192
    v_mfma_f32_16x16x32_bf16 v[48:51], v[204:207], v[188:191], v[48:51]
    ds_read_b64_tr_b16 v[248:249], v2 offset:4352
    v_mfma_f32_16x16x32_bf16 v[32:35], v[204:207], v[180:183], v[32:35]
    ds_read_b64_tr_b16 v[250:251], v2 offset:12544
    s_waitcnt lgkmcnt(8)
    v_mfma_f32_16x16x32_bf16 v[20:23], v[228:231], v[212:215], v[20:23]
    ds_read_b64_tr_b16 v[184:185], v7 offset:0
    s_waitcnt lgkmcnt(7)
    v_mfma_f32_16x16x32_bf16 v[36:39], v[228:231], v[220:223], v[36:39]
    ds_read_b64_tr_b16 v[186:187], v7 offset:8192
    s_waitcnt lgkmcnt(6)
    v_mfma_f32_16x16x32_bf16 v[40:43], v[208:211], v[220:223], v[40:43]
    ds_read_b64_tr_b16 v[236:237], v3 offset:4352
    v_mfma_f32_16x16x32_bf16 v[24:27], v[208:211], v[212:215], v[24:27]
    ds_read_b64_tr_b16 v[238:239], v3 offset:12544
    s_waitcnt lgkmcnt(6)
    v_mfma_f32_16x16x32_bf16 v[56:59], v[208:211], v[232:235], v[56:59]
    s_barrier
    ds_read_b64_tr_b16 v[192:193], v2 offset:20480
    v_mfma_f32_16x16x32_bf16 v[52:55], v[228:231], v[232:235], v[52:55]
    ds_read_b64_tr_b16 v[194:195], v2 offset:28672
    s_waitcnt lgkmcnt(6)
    v_mfma_f32_16x16x32_bf16 v[60:63], v[248:251], v[232:235], v[60:63]
    ds_read_b64_tr_b16 v[244:245], v4 offset:16384
    v_mfma_f32_16x16x32_bf16 v[44:47], v[248:251], v[220:223], v[44:47]
    ds_read_b64_tr_b16 v[246:247], v4 offset:24576
    v_mfma_f32_16x16x32_bf16 v[28:31], v[248:251], v[212:215], v[28:31]
    ds_read_b64_tr_b16 v[252:253], v5 offset:16384
    s_waitcnt lgkmcnt(7)
    v_mfma_f32_16x16x32_bf16 v[76:79], v[248:251], v[184:187], v[76:79]
    ds_read_b64_tr_b16 v[254:255], v5 offset:24576
    v_mfma_f32_16x16x32_bf16 v[72:75], v[208:211], v[184:187], v[72:75]
    ds_read_b64_tr_b16 v[240:241], v3 offset:20480
    v_mfma_f32_16x16x32_bf16 v[68:71], v[228:231], v[184:187], v[68:71]
    ds_read_b64_tr_b16 v[242:243], v3 offset:28672
    s_waitcnt lgkmcnt(8)
    v_mfma_f32_16x16x32_bf16 v[80:83], v[236:239], v[184:187], v[80:83]
    ds_read_b64_tr_b16 v[172:173], v6 offset:16384
    v_mfma_f32_16x16x32_bf16 v[64:67], v[236:239], v[232:235], v[64:67]
    ds_read_b64_tr_b16 v[174:175], v6 offset:24576
    v_mfma_f32_16x16x32_bf16 v[48:51], v[236:239], v[220:223], v[48:51]
    ds_read_b64_tr_b16 v[176:177], v2 offset:20736
    v_mfma_f32_16x16x32_bf16 v[32:35], v[236:239], v[212:215], v[32:35]
    ds_read_b64_tr_b16 v[178:179], v2 offset:28928
    s_waitcnt lgkmcnt(8)
    v_mfma_f32_16x16x32_bf16 v[20:23], v[192:195], v[244:247], v[20:23]
    ds_read_b64_tr_b16 v[216:217], v7 offset:16384
    s_waitcnt lgkmcnt(7)
    v_mfma_f32_16x16x32_bf16 v[36:39], v[192:195], v[252:255], v[36:39]
    ds_read_b64_tr_b16 v[218:219], v7 offset:24576
    s_waitcnt lgkmcnt(6)
    v_mfma_f32_16x16x32_bf16 v[40:43], v[240:243], v[252:255], v[40:43]
    ds_read_b64_tr_b16 v[196:197], v3 offset:20736
    v_mfma_f32_16x16x32_bf16 v[24:27], v[240:243], v[244:247], v[24:27]
    ds_read_b64_tr_b16 v[198:199], v3 offset:28928
    s_waitcnt lgkmcnt(6)
    v_mfma_f32_16x16x32_bf16 v[56:59], v[240:243], v[172:175], v[56:59]
    s_barrier
    ds_read_b64_tr_b16 v[224:225], v2 offset:36864
    v_mfma_f32_16x16x32_bf16 v[52:55], v[192:195], v[172:175], v[52:55]
    ds_read_b64_tr_b16 v[226:227], v2 offset:45056
    s_waitcnt lgkmcnt(6)
    v_mfma_f32_16x16x32_bf16 v[60:63], v[176:179], v[172:175], v[60:63]
    ds_read_b64_tr_b16 v[188:189], v4 offset:32768
    v_mfma_f32_16x16x32_bf16 v[44:47], v[176:179], v[252:255], v[44:47]
    ds_read_b64_tr_b16 v[190:191], v4 offset:40960
    v_mfma_f32_16x16x32_bf16 v[28:31], v[176:179], v[244:247], v[28:31]
    ds_read_b64_tr_b16 v[200:201], v5 offset:32768
    s_waitcnt lgkmcnt(7)
    v_mfma_f32_16x16x32_bf16 v[76:79], v[176:179], v[216:219], v[76:79]
    ds_read_b64_tr_b16 v[202:203], v5 offset:40960
    v_mfma_f32_16x16x32_bf16 v[72:75], v[240:243], v[216:219], v[72:75]
    ds_read_b64_tr_b16 v[180:181], v3 offset:36864
    v_mfma_f32_16x16x32_bf16 v[68:71], v[192:195], v[216:219], v[68:71]
    ds_read_b64_tr_b16 v[182:183], v3 offset:45056
    s_waitcnt lgkmcnt(8)
    v_mfma_f32_16x16x32_bf16 v[80:83], v[196:199], v[216:219], v[80:83]
    ds_read_b64_tr_b16 v[204:205], v6 offset:32768
    v_mfma_f32_16x16x32_bf16 v[64:67], v[196:199], v[172:175], v[64:67]
    ds_read_b64_tr_b16 v[206:207], v6 offset:40960
    v_mfma_f32_16x16x32_bf16 v[48:51], v[196:199], v[252:255], v[48:51]
    ds_read_b64_tr_b16 v[208:209], v2 offset:37120
    v_mfma_f32_16x16x32_bf16 v[32:35], v[196:199], v[244:247], v[32:35]
    ds_read_b64_tr_b16 v[210:211], v2 offset:45312
    s_waitcnt lgkmcnt(8)
    v_mfma_f32_16x16x32_bf16 v[20:23], v[224:227], v[188:191], v[20:23]
    ds_read_b64_tr_b16 v[248:249], v7 offset:32768
    s_waitcnt lgkmcnt(7)
    v_mfma_f32_16x16x32_bf16 v[36:39], v[224:227], v[200:203], v[36:39]
    ds_read_b64_tr_b16 v[250:251], v7 offset:40960
    s_waitcnt lgkmcnt(6)
    v_mfma_f32_16x16x32_bf16 v[40:43], v[180:183], v[200:203], v[40:43]
    ds_read_b64_tr_b16 v[228:229], v3 offset:37120
    v_mfma_f32_16x16x32_bf16 v[24:27], v[180:183], v[188:191], v[24:27]
    ds_read_b64_tr_b16 v[230:231], v3 offset:45312
    s_waitcnt lgkmcnt(6)
    v_mfma_f32_16x16x32_bf16 v[56:59], v[180:183], v[204:207], v[56:59]
    s_barrier
    ds_read_b64_tr_b16 v[124:125], v9 offset:0
    ds_read_b64_tr_b16 v[126:127], v9 offset:8192
    ds_read_b64_tr_b16 v[128:129], v14 offset:0
    ds_read_b64_tr_b16 v[130:131], v14 offset:8192
    ds_read_b64_tr_b16 v[184:185], v2 offset:53248
    v_mfma_f32_16x16x32_bf16 v[52:55], v[224:227], v[204:207], v[52:55]
    ds_read_b64_tr_b16 v[186:187], v2 offset:61440
    s_waitcnt lgkmcnt(10)
    v_mfma_f32_16x16x32_bf16 v[60:63], v[208:211], v[204:207], v[60:63]
    ds_read_b64_tr_b16 v[220:221], v4 offset:49152
    v_mfma_f32_16x16x32_bf16 v[44:47], v[208:211], v[200:203], v[44:47]
    ds_read_b64_tr_b16 v[222:223], v4 offset:57344
    v_mfma_f32_16x16x32_bf16 v[28:31], v[208:211], v[188:191], v[28:31]
    ds_read_b64_tr_b16 v[232:233], v5 offset:49152
    s_waitcnt lgkmcnt(11)
    v_mfma_f32_16x16x32_bf16 v[76:79], v[208:211], v[248:251], v[76:79]
    ds_read_b64_tr_b16 v[234:235], v5 offset:57344
    v_mfma_f32_16x16x32_bf16 v[72:75], v[180:183], v[248:251], v[72:75]
    ds_read_b64_tr_b16 v[212:213], v3 offset:53248
    v_mfma_f32_16x16x32_bf16 v[68:71], v[224:227], v[248:251], v[68:71]
    ds_read_b64_tr_b16 v[214:215], v3 offset:61440
    s_waitcnt lgkmcnt(12)
    v_mfma_f32_16x16x32_bf16 v[80:83], v[228:231], v[248:251], v[80:83]
    ds_read_b64_tr_b16 v[236:237], v6 offset:49152
    v_mfma_f32_16x16x32_bf16 v[64:67], v[228:231], v[204:207], v[64:67]
    ds_read_b64_tr_b16 v[238:239], v6 offset:57344
    v_mfma_f32_16x16x32_bf16 v[48:51], v[228:231], v[200:203], v[48:51]
    ds_read_b64_tr_b16 v[240:241], v2 offset:53504
    v_mfma_f32_16x16x32_bf16 v[32:35], v[228:231], v[188:191], v[32:35]
    ds_read_b64_tr_b16 v[242:243], v2 offset:61696
    s_waitcnt lgkmcnt(8)
    v_mfma_f32_16x16x32_bf16 v[20:23], v[184:187], v[220:223], v[20:23]
    ds_read_b64_tr_b16 v[176:177], v7 offset:49152
    s_waitcnt lgkmcnt(7)
    v_mfma_f32_16x16x32_bf16 v[36:39], v[184:187], v[232:235], v[36:39]
    ds_read_b64_tr_b16 v[178:179], v7 offset:57344
    s_waitcnt lgkmcnt(6)
    v_mfma_f32_16x16x32_bf16 v[40:43], v[212:215], v[232:235], v[40:43]
    ds_read_b64_tr_b16 v[192:193], v3 offset:53504
    v_mfma_f32_16x16x32_bf16 v[24:27], v[212:215], v[220:223], v[24:27]
    ds_read_b64_tr_b16 v[194:195], v3 offset:61696
    s_waitcnt lgkmcnt(6)
    v_mfma_f32_16x16x32_bf16 v[56:59], v[212:215], v[236:239], v[56:59]
    v_xor_b32 v2, 0x10000, v2
    v_xor_b32 v3, 0x10000, v3
    v_xor_b32 v4, 0x10000, v4
    v_xor_b32 v5, 0x10000, v5
    v_xor_b32 v6, 0x10000, v6
    v_xor_b32 v7, 0x10000, v7
    v_xor_b32 v9, 0x10000, v9
    v_xor_b32 v14, 0x10000, v14
    s_barrier
    buffer_load_dwordx2 v[110:111], v112, s[28:31], s20 offen offset:128 sc1
    ds_read_b64_tr_b16 v[216:217], v2 offset:4096
    v_mfma_f32_16x16x32_bf16 v[52:55], v[184:187], v[236:239], v[52:55]
    ds_read_b64_tr_b16 v[218:219], v2 offset:12288
    s_waitcnt lgkmcnt(6)
    v_mfma_f32_16x16x32_bf16 v[60:63], v[240:243], v[236:239], v[60:63]
    ds_read_b64_tr_b16 v[252:253], v4 offset:0
    v_mfma_f32_16x16x32_bf16 v[44:47], v[240:243], v[232:235], v[44:47]
    ds_read_b64_tr_b16 v[254:255], v4 offset:8192
    v_mfma_f32_16x16x32_bf16 v[28:31], v[240:243], v[220:223], v[28:31]
    ds_read_b64_tr_b16 v[172:173], v5 offset:0
    s_waitcnt lgkmcnt(7)
    v_mfma_f32_16x16x32_bf16 v[76:79], v[240:243], v[176:179], v[76:79]
    ds_read_b64_tr_b16 v[174:175], v5 offset:8192
    v_mfma_f32_16x16x32_bf16 v[72:75], v[212:215], v[176:179], v[72:75]
    ds_read_b64_tr_b16 v[244:245], v3 offset:4096
    v_mfma_f32_16x16x32_bf16 v[68:71], v[184:187], v[176:179], v[68:71]
    ds_read_b64_tr_b16 v[246:247], v3 offset:12288
    s_waitcnt lgkmcnt(8)
    v_mfma_f32_16x16x32_bf16 v[80:83], v[192:195], v[176:179], v[80:83]
    ds_read_b64_tr_b16 v[196:197], v6 offset:0
    v_mfma_f32_16x16x32_bf16 v[64:67], v[192:195], v[236:239], v[64:67]
    ds_read_b64_tr_b16 v[198:199], v6 offset:8192
    v_mfma_f32_16x16x32_bf16 v[48:51], v[192:195], v[232:235], v[48:51]
    ds_read_b64_tr_b16 v[180:181], v2 offset:4352
    v_mfma_f32_16x16x32_bf16 v[32:35], v[192:195], v[220:223], v[32:35]
    ds_read_b64_tr_b16 v[182:183], v2 offset:12544
    s_waitcnt lgkmcnt(8)
    v_mfma_f32_16x16x32_bf16 v[20:23], v[216:219], v[252:255], v[20:23]
    ds_read_b64_tr_b16 v[208:209], v7 offset:0
    s_waitcnt lgkmcnt(7)
    v_mfma_f32_16x16x32_bf16 v[36:39], v[216:219], v[172:175], v[36:39]
    ds_read_b64_tr_b16 v[210:211], v7 offset:8192
    s_waitcnt lgkmcnt(6)
    v_mfma_f32_16x16x32_bf16 v[40:43], v[244:247], v[172:175], v[40:43]
    ds_read_b64_tr_b16 v[224:225], v3 offset:4352
    v_mfma_f32_16x16x32_bf16 v[24:27], v[244:247], v[252:255], v[24:27]
    ds_read_b64_tr_b16 v[226:227], v3 offset:12544
    s_waitcnt lgkmcnt(6)
    v_mfma_f32_16x16x32_bf16 v[56:59], v[244:247], v[196:199], v[56:59]
    s_barrier
    ds_read_b64_tr_b16 v[248:249], v2 offset:20480
    v_mfma_f32_16x16x32_bf16 v[52:55], v[216:219], v[196:199], v[52:55]
    ds_read_b64_tr_b16 v[250:251], v2 offset:28672
    s_waitcnt lgkmcnt(6)
    v_mfma_f32_16x16x32_bf16 v[60:63], v[180:183], v[196:199], v[60:63]
    ds_read_b64_tr_b16 v[200:201], v4 offset:16384
    v_mfma_f32_16x16x32_bf16 v[44:47], v[180:183], v[172:175], v[44:47]
    ds_read_b64_tr_b16 v[202:203], v4 offset:24576
    v_mfma_f32_16x16x32_bf16 v[28:31], v[180:183], v[252:255], v[28:31]
    ds_read_b64_tr_b16 v[204:205], v5 offset:16384
    s_waitcnt lgkmcnt(7)
    v_mfma_f32_16x16x32_bf16 v[76:79], v[180:183], v[208:211], v[76:79]
    ds_read_b64_tr_b16 v[206:207], v5 offset:24576
    v_mfma_f32_16x16x32_bf16 v[72:75], v[244:247], v[208:211], v[72:75]
    ds_read_b64_tr_b16 v[188:189], v3 offset:20480
    v_mfma_f32_16x16x32_bf16 v[68:71], v[216:219], v[208:211], v[68:71]
    ds_read_b64_tr_b16 v[190:191], v3 offset:28672
    s_waitcnt lgkmcnt(8)
    v_mfma_f32_16x16x32_bf16 v[80:83], v[224:227], v[208:211], v[80:83]
    ds_read_b64_tr_b16 v[228:229], v6 offset:16384
    v_mfma_f32_16x16x32_bf16 v[64:67], v[224:227], v[196:199], v[64:67]
    ds_read_b64_tr_b16 v[230:231], v6 offset:24576
    v_mfma_f32_16x16x32_bf16 v[48:51], v[224:227], v[172:175], v[48:51]
    ds_read_b64_tr_b16 v[212:213], v2 offset:20736
    v_mfma_f32_16x16x32_bf16 v[32:35], v[224:227], v[252:255], v[32:35]
    ds_read_b64_tr_b16 v[214:215], v2 offset:28928
    s_waitcnt lgkmcnt(8)
    v_mfma_f32_16x16x32_bf16 v[20:23], v[248:251], v[200:203], v[20:23]
    ds_read_b64_tr_b16 v[240:241], v7 offset:16384
    s_waitcnt lgkmcnt(7)
    v_mfma_f32_16x16x32_bf16 v[36:39], v[248:251], v[204:207], v[36:39]
    ds_read_b64_tr_b16 v[242:243], v7 offset:24576
    s_waitcnt lgkmcnt(6)
    v_mfma_f32_16x16x32_bf16 v[40:43], v[188:191], v[204:207], v[40:43]
    ds_read_b64_tr_b16 v[184:185], v3 offset:20736
    v_mfma_f32_16x16x32_bf16 v[24:27], v[188:191], v[200:203], v[24:27]
    ds_read_b64_tr_b16 v[186:187], v3 offset:28928
    s_waitcnt lgkmcnt(6)
    v_mfma_f32_16x16x32_bf16 v[56:59], v[188:191], v[228:231], v[56:59]
    s_barrier
    ds_read_b64_tr_b16 v[176:177], v2 offset:36864
    v_mfma_f32_16x16x32_bf16 v[52:55], v[248:251], v[228:231], v[52:55]
    ds_read_b64_tr_b16 v[178:179], v2 offset:45056
    s_waitcnt lgkmcnt(6)
    v_mfma_f32_16x16x32_bf16 v[60:63], v[212:215], v[228:231], v[60:63]
    ds_read_b64_tr_b16 v[232:233], v4 offset:32768
    v_mfma_f32_16x16x32_bf16 v[44:47], v[212:215], v[204:207], v[44:47]
    ds_read_b64_tr_b16 v[234:235], v4 offset:40960
    v_mfma_f32_16x16x32_bf16 v[28:31], v[212:215], v[200:203], v[28:31]
    ds_read_b64_tr_b16 v[236:237], v5 offset:32768
    s_waitcnt lgkmcnt(7)
    v_mfma_f32_16x16x32_bf16 v[76:79], v[212:215], v[240:243], v[76:79]
    ds_read_b64_tr_b16 v[238:239], v5 offset:40960
    v_mfma_f32_16x16x32_bf16 v[72:75], v[188:191], v[240:243], v[72:75]
    ds_read_b64_tr_b16 v[220:221], v3 offset:36864
    v_mfma_f32_16x16x32_bf16 v[68:71], v[248:251], v[240:243], v[68:71]
    ds_read_b64_tr_b16 v[222:223], v3 offset:45056
    s_waitcnt lgkmcnt(8)
    v_mfma_f32_16x16x32_bf16 v[80:83], v[184:187], v[240:243], v[80:83]
    ds_read_b64_tr_b16 v[192:193], v6 offset:32768
    v_mfma_f32_16x16x32_bf16 v[64:67], v[184:187], v[228:231], v[64:67]
    ds_read_b64_tr_b16 v[194:195], v6 offset:40960
    v_mfma_f32_16x16x32_bf16 v[48:51], v[184:187], v[204:207], v[48:51]
    ds_read_b64_tr_b16 v[244:245], v2 offset:37120
    v_mfma_f32_16x16x32_bf16 v[32:35], v[184:187], v[200:203], v[32:35]
    ds_read_b64_tr_b16 v[246:247], v2 offset:45312
    s_waitcnt lgkmcnt(8)
    v_mfma_f32_16x16x32_bf16 v[20:23], v[176:179], v[232:235], v[20:23]
    ds_read_b64_tr_b16 v[180:181], v7 offset:32768
    s_waitcnt lgkmcnt(7)
    v_mfma_f32_16x16x32_bf16 v[36:39], v[176:179], v[236:239], v[36:39]
    ds_read_b64_tr_b16 v[182:183], v7 offset:40960
    s_waitcnt lgkmcnt(6)
    v_mfma_f32_16x16x32_bf16 v[40:43], v[220:223], v[236:239], v[40:43]
    ds_read_b64_tr_b16 v[216:217], v3 offset:37120
    v_mfma_f32_16x16x32_bf16 v[24:27], v[220:223], v[232:235], v[24:27]
    ds_read_b64_tr_b16 v[218:219], v3 offset:45312
    s_waitcnt lgkmcnt(6)
    v_mfma_f32_16x16x32_bf16 v[56:59], v[220:223], v[192:195], v[56:59]
    s_barrier
    ds_read_b64_tr_b16 v[132:133], v9 offset:0
    ds_read_b64_tr_b16 v[134:135], v9 offset:8192
    ds_read_b64_tr_b16 v[136:137], v14 offset:0
    ds_read_b64_tr_b16 v[138:139], v14 offset:8192
    ds_read_b64_tr_b16 v[208:209], v2 offset:53248
    v_mfma_f32_16x16x32_bf16 v[52:55], v[176:179], v[192:195], v[52:55]
    ds_read_b64_tr_b16 v[210:211], v2 offset:61440
    s_waitcnt lgkmcnt(10)
    v_mfma_f32_16x16x32_bf16 v[60:63], v[244:247], v[192:195], v[60:63]
    ds_read_b64_tr_b16 v[172:173], v4 offset:49152
    v_mfma_f32_16x16x32_bf16 v[44:47], v[244:247], v[236:239], v[44:47]
    ds_read_b64_tr_b16 v[174:175], v4 offset:57344
    v_mfma_f32_16x16x32_bf16 v[28:31], v[244:247], v[232:235], v[28:31]
    ds_read_b64_tr_b16 v[196:197], v5 offset:49152
    s_waitcnt lgkmcnt(11)
    v_mfma_f32_16x16x32_bf16 v[76:79], v[244:247], v[180:183], v[76:79]
    ds_read_b64_tr_b16 v[198:199], v5 offset:57344
    v_mfma_f32_16x16x32_bf16 v[72:75], v[220:223], v[180:183], v[72:75]
    ds_read_b64_tr_b16 v[252:253], v3 offset:53248
    v_mfma_f32_16x16x32_bf16 v[68:71], v[176:179], v[180:183], v[68:71]
    ds_read_b64_tr_b16 v[254:255], v3 offset:61440
    s_waitcnt lgkmcnt(12)
    v_mfma_f32_16x16x32_bf16 v[80:83], v[216:219], v[180:183], v[80:83]
    ds_read_b64_tr_b16 v[224:225], v6 offset:49152
    v_mfma_f32_16x16x32_bf16 v[64:67], v[216:219], v[192:195], v[64:67]
    ds_read_b64_tr_b16 v[226:227], v6 offset:57344
    v_mfma_f32_16x16x32_bf16 v[48:51], v[216:219], v[236:239], v[48:51]
    ds_read_b64_tr_b16 v[188:189], v2 offset:53504
    v_mfma_f32_16x16x32_bf16 v[32:35], v[216:219], v[232:235], v[32:35]
    ds_read_b64_tr_b16 v[190:191], v2 offset:61696
    s_waitcnt lgkmcnt(8)
    v_mfma_f32_16x16x32_bf16 v[20:23], v[208:211], v[172:175], v[20:23]
    ds_read_b64_tr_b16 v[212:213], v7 offset:49152
    s_waitcnt lgkmcnt(7)
    v_mfma_f32_16x16x32_bf16 v[36:39], v[208:211], v[196:199], v[36:39]
    ds_read_b64_tr_b16 v[214:215], v7 offset:57344
    s_waitcnt lgkmcnt(6)
    v_mfma_f32_16x16x32_bf16 v[40:43], v[252:255], v[196:199], v[40:43]
    ds_read_b64_tr_b16 v[248:249], v3 offset:53504
    v_mfma_f32_16x16x32_bf16 v[24:27], v[252:255], v[172:175], v[24:27]
    ds_read_b64_tr_b16 v[250:251], v3 offset:61696
    s_waitcnt lgkmcnt(6)
    v_mfma_f32_16x16x32_bf16 v[56:59], v[252:255], v[224:227], v[56:59]
    v_xor_b32 v2, 0x10000, v2
    v_xor_b32 v3, 0x10000, v3
    v_xor_b32 v4, 0x10000, v4
    v_xor_b32 v5, 0x10000, v5
    v_xor_b32 v6, 0x10000, v6
    v_xor_b32 v7, 0x10000, v7
    v_xor_b32 v9, 0x10000, v9
    v_xor_b32 v14, 0x10000, v14
    s_barrier
    ds_read_b64_tr_b16 v[240:241], v2 offset:4096
    v_mfma_f32_16x16x32_bf16 v[52:55], v[208:211], v[224:227], v[52:55]
    ds_read_b64_tr_b16 v[242:243], v2 offset:12288
    s_waitcnt lgkmcnt(6)
    v_mfma_f32_16x16x32_bf16 v[60:63], v[188:191], v[224:227], v[60:63]
    ds_read_b64_tr_b16 v[204:205], v4 offset:0
    v_mfma_f32_16x16x32_bf16 v[44:47], v[188:191], v[196:199], v[44:47]
    ds_read_b64_tr_b16 v[206:207], v4 offset:8192
    v_mfma_f32_16x16x32_bf16 v[28:31], v[188:191], v[172:175], v[28:31]
    ds_read_b64_tr_b16 v[228:229], v5 offset:0
    s_waitcnt lgkmcnt(7)
    v_mfma_f32_16x16x32_bf16 v[76:79], v[188:191], v[212:215], v[76:79]
    ds_read_b64_tr_b16 v[230:231], v5 offset:8192
    v_mfma_f32_16x16x32_bf16 v[72:75], v[252:255], v[212:215], v[72:75]
    ds_read_b64_tr_b16 v[200:201], v3 offset:4096
    v_mfma_f32_16x16x32_bf16 v[68:71], v[208:211], v[212:215], v[68:71]
    ds_read_b64_tr_b16 v[202:203], v3 offset:12288
    s_waitcnt lgkmcnt(8)
    v_mfma_f32_16x16x32_bf16 v[80:83], v[248:251], v[212:215], v[80:83]
    ds_read_b64_tr_b16 v[184:185], v6 offset:0
    v_mfma_f32_16x16x32_bf16 v[64:67], v[248:251], v[224:227], v[64:67]
    ds_read_b64_tr_b16 v[186:187], v6 offset:8192
    v_mfma_f32_16x16x32_bf16 v[48:51], v[248:251], v[196:199], v[48:51]
    ds_read_b64_tr_b16 v[220:221], v2 offset:4352
    v_mfma_f32_16x16x32_bf16 v[32:35], v[248:251], v[172:175], v[32:35]
    ds_read_b64_tr_b16 v[222:223], v2 offset:12544
    s_waitcnt lgkmcnt(8)
    v_mfma_f32_16x16x32_bf16 v[20:23], v[240:243], v[204:207], v[20:23]
    ds_read_b64_tr_b16 v[244:245], v7 offset:0
    s_waitcnt lgkmcnt(7)
    v_mfma_f32_16x16x32_bf16 v[36:39], v[240:243], v[228:231], v[36:39]
    ds_read_b64_tr_b16 v[246:247], v7 offset:8192
    s_waitcnt lgkmcnt(6)
    v_mfma_f32_16x16x32_bf16 v[40:43], v[200:203], v[228:231], v[40:43]
    ds_read_b64_tr_b16 v[176:177], v3 offset:4352
    v_mfma_f32_16x16x32_bf16 v[24:27], v[200:203], v[204:207], v[24:27]
    ds_read_b64_tr_b16 v[178:179], v3 offset:12544
    s_waitcnt lgkmcnt(6)
    v_mfma_f32_16x16x32_bf16 v[56:59], v[200:203], v[184:187], v[56:59]
    s_barrier
    ds_read_b64_tr_b16 v[180:181], v2 offset:20480
    v_mfma_f32_16x16x32_bf16 v[52:55], v[240:243], v[184:187], v[52:55]
    ds_read_b64_tr_b16 v[182:183], v2 offset:28672
    s_waitcnt lgkmcnt(6)
    v_mfma_f32_16x16x32_bf16 v[60:63], v[220:223], v[184:187], v[60:63]
    ds_read_b64_tr_b16 v[236:237], v4 offset:16384
    v_mfma_f32_16x16x32_bf16 v[44:47], v[220:223], v[228:231], v[44:47]
    ds_read_b64_tr_b16 v[238:239], v4 offset:24576
    v_mfma_f32_16x16x32_bf16 v[28:31], v[220:223], v[204:207], v[28:31]
    ds_read_b64_tr_b16 v[192:193], v5 offset:16384
    s_waitcnt lgkmcnt(7)
    v_mfma_f32_16x16x32_bf16 v[76:79], v[220:223], v[244:247], v[76:79]
    ds_read_b64_tr_b16 v[194:195], v5 offset:24576
    v_mfma_f32_16x16x32_bf16 v[72:75], v[200:203], v[244:247], v[72:75]
    ds_read_b64_tr_b16 v[232:233], v3 offset:20480
    v_mfma_f32_16x16x32_bf16 v[68:71], v[240:243], v[244:247], v[68:71]
    ds_read_b64_tr_b16 v[234:235], v3 offset:28672
    s_waitcnt lgkmcnt(8)
    v_mfma_f32_16x16x32_bf16 v[80:83], v[176:179], v[244:247], v[80:83]
    ds_read_b64_tr_b16 v[216:217], v6 offset:16384
    v_mfma_f32_16x16x32_bf16 v[64:67], v[176:179], v[184:187], v[64:67]
    ds_read_b64_tr_b16 v[218:219], v6 offset:24576
    v_mfma_f32_16x16x32_bf16 v[48:51], v[176:179], v[228:231], v[48:51]
    ds_read_b64_tr_b16 v[252:253], v2 offset:20736
    v_mfma_f32_16x16x32_bf16 v[32:35], v[176:179], v[204:207], v[32:35]
    ds_read_b64_tr_b16 v[254:255], v2 offset:28928
    s_waitcnt lgkmcnt(8)
    v_mfma_f32_16x16x32_bf16 v[20:23], v[180:183], v[236:239], v[20:23]
    ds_read_b64_tr_b16 v[188:189], v7 offset:16384
    s_waitcnt lgkmcnt(7)
    v_mfma_f32_16x16x32_bf16 v[36:39], v[180:183], v[192:195], v[36:39]
    ds_read_b64_tr_b16 v[190:191], v7 offset:24576
    s_waitcnt lgkmcnt(6)
    v_mfma_f32_16x16x32_bf16 v[40:43], v[232:235], v[192:195], v[40:43]
    ds_read_b64_tr_b16 v[208:209], v3 offset:20736
    v_mfma_f32_16x16x32_bf16 v[24:27], v[232:235], v[236:239], v[24:27]
    ds_read_b64_tr_b16 v[210:211], v3 offset:28928
    s_waitcnt lgkmcnt(6)
    v_mfma_f32_16x16x32_bf16 v[56:59], v[232:235], v[216:219], v[56:59]
    s_barrier
    ds_read_b64_tr_b16 v[212:213], v2 offset:36864
    v_mfma_f32_16x16x32_bf16 v[52:55], v[180:183], v[216:219], v[52:55]
    ds_read_b64_tr_b16 v[214:215], v2 offset:45056
    s_waitcnt lgkmcnt(6)
    v_mfma_f32_16x16x32_bf16 v[60:63], v[252:255], v[216:219], v[60:63]
    ds_read_b64_tr_b16 v[196:197], v4 offset:32768
    v_mfma_f32_16x16x32_bf16 v[44:47], v[252:255], v[192:195], v[44:47]
    ds_read_b64_tr_b16 v[198:199], v4 offset:40960
    v_mfma_f32_16x16x32_bf16 v[28:31], v[252:255], v[236:239], v[28:31]
    ds_read_b64_tr_b16 v[224:225], v5 offset:32768
    s_waitcnt lgkmcnt(7)
    v_mfma_f32_16x16x32_bf16 v[76:79], v[252:255], v[188:191], v[76:79]
    ds_read_b64_tr_b16 v[226:227], v5 offset:40960
    v_mfma_f32_16x16x32_bf16 v[72:75], v[232:235], v[188:191], v[72:75]
    ds_read_b64_tr_b16 v[172:173], v3 offset:36864
    v_mfma_f32_16x16x32_bf16 v[68:71], v[180:183], v[188:191], v[68:71]
    ds_read_b64_tr_b16 v[174:175], v3 offset:45056
    s_waitcnt lgkmcnt(8)
    v_mfma_f32_16x16x32_bf16 v[80:83], v[208:211], v[188:191], v[80:83]
    ds_read_b64_tr_b16 v[248:249], v6 offset:32768
    v_mfma_f32_16x16x32_bf16 v[64:67], v[208:211], v[216:219], v[64:67]
    ds_read_b64_tr_b16 v[250:251], v6 offset:40960
    v_mfma_f32_16x16x32_bf16 v[48:51], v[208:211], v[192:195], v[48:51]
    ds_read_b64_tr_b16 v[200:201], v2 offset:37120
    v_mfma_f32_16x16x32_bf16 v[32:35], v[208:211], v[236:239], v[32:35]
    ds_read_b64_tr_b16 v[202:203], v2 offset:45312
    s_waitcnt lgkmcnt(8)
    v_mfma_f32_16x16x32_bf16 v[20:23], v[212:215], v[196:199], v[20:23]
    ds_read_b64_tr_b16 v[220:221], v7 offset:32768
    s_waitcnt lgkmcnt(7)
    v_mfma_f32_16x16x32_bf16 v[36:39], v[212:215], v[224:227], v[36:39]
    ds_read_b64_tr_b16 v[222:223], v7 offset:40960
    s_waitcnt lgkmcnt(6)
    v_mfma_f32_16x16x32_bf16 v[40:43], v[172:175], v[224:227], v[40:43]
    ds_read_b64_tr_b16 v[240:241], v3 offset:37120
    v_mfma_f32_16x16x32_bf16 v[24:27], v[172:175], v[196:199], v[24:27]
    ds_read_b64_tr_b16 v[242:243], v3 offset:45312
    s_waitcnt lgkmcnt(6)
    v_mfma_f32_16x16x32_bf16 v[56:59], v[172:175], v[248:251], v[56:59]
    s_barrier
    ds_read_b64_tr_b16 v[140:141], v9 offset:0
    ds_read_b64_tr_b16 v[142:143], v9 offset:8192
    ds_read_b64_tr_b16 v[144:145], v14 offset:0
    ds_read_b64_tr_b16 v[146:147], v14 offset:8192
    ds_read_b64_tr_b16 v[244:245], v2 offset:53248
    v_mfma_f32_16x16x32_bf16 v[52:55], v[212:215], v[248:251], v[52:55]
    ds_read_b64_tr_b16 v[246:247], v2 offset:61440
    s_waitcnt lgkmcnt(10)
    v_mfma_f32_16x16x32_bf16 v[60:63], v[200:203], v[248:251], v[60:63]
    ds_read_b64_tr_b16 v[228:229], v4 offset:49152
    v_mfma_f32_16x16x32_bf16 v[44:47], v[200:203], v[224:227], v[44:47]
    ds_read_b64_tr_b16 v[230:231], v4 offset:57344
    v_mfma_f32_16x16x32_bf16 v[28:31], v[200:203], v[196:199], v[28:31]
    ds_read_b64_tr_b16 v[184:185], v5 offset:49152
    s_waitcnt lgkmcnt(11)
    v_mfma_f32_16x16x32_bf16 v[76:79], v[200:203], v[220:223], v[76:79]
    ds_read_b64_tr_b16 v[186:187], v5 offset:57344
    v_mfma_f32_16x16x32_bf16 v[72:75], v[172:175], v[220:223], v[72:75]
    ds_read_b64_tr_b16 v[204:205], v3 offset:53248
    v_mfma_f32_16x16x32_bf16 v[68:71], v[212:215], v[220:223], v[68:71]
    ds_read_b64_tr_b16 v[206:207], v3 offset:61440
    s_waitcnt lgkmcnt(12)
    v_mfma_f32_16x16x32_bf16 v[80:83], v[240:243], v[220:223], v[80:83]
    ds_read_b64_tr_b16 v[176:177], v6 offset:49152
    v_mfma_f32_16x16x32_bf16 v[64:67], v[240:243], v[248:251], v[64:67]
    ds_read_b64_tr_b16 v[178:179], v6 offset:57344
    v_mfma_f32_16x16x32_bf16 v[48:51], v[240:243], v[224:227], v[48:51]
    ds_read_b64_tr_b16 v[232:233], v2 offset:53504
    v_mfma_f32_16x16x32_bf16 v[32:35], v[240:243], v[196:199], v[32:35]
    ds_read_b64_tr_b16 v[234:235], v2 offset:61696
    s_waitcnt lgkmcnt(8)
    v_mfma_f32_16x16x32_bf16 v[20:23], v[244:247], v[228:231], v[20:23]
    ds_read_b64_tr_b16 v[252:253], v7 offset:49152
    s_waitcnt lgkmcnt(7)
    v_mfma_f32_16x16x32_bf16 v[36:39], v[244:247], v[184:187], v[36:39]
    ds_read_b64_tr_b16 v[254:255], v7 offset:57344
    s_waitcnt lgkmcnt(6)
    v_mfma_f32_16x16x32_bf16 v[40:43], v[204:207], v[184:187], v[40:43]
    ds_read_b64_tr_b16 v[180:181], v3 offset:53504
    v_mfma_f32_16x16x32_bf16 v[24:27], v[204:207], v[228:231], v[24:27]
    ds_read_b64_tr_b16 v[182:183], v3 offset:61696
    s_waitcnt lgkmcnt(6)
    v_mfma_f32_16x16x32_bf16 v[56:59], v[204:207], v[176:179], v[56:59]
    s_waitcnt vmcnt(0)
    s_barrier
    v_mfma_f32_16x16x32_bf16 v[52:55], v[244:247], v[176:179], v[52:55]
    v_cmp_ne_u32 vcc, s63, v110
    s_waitcnt lgkmcnt(4)
    v_mfma_f32_16x16x32_bf16 v[60:63], v[232:235], v[176:179], v[60:63]
    v_cmp_ne_u32 s[52:53], s64, v111
    v_mfma_f32_16x16x32_bf16 v[44:47], v[232:235], v[184:187], v[44:47]
    v_mov_b32 v2, v8
    v_mfma_f32_16x16x32_bf16 v[28:31], v[232:235], v[228:231], v[28:31]
    s_or_b64 vcc, vcc, s[52:53]
    s_cbranch_scc1 L_ann_wait
L_ann_ok:
    s_waitcnt lgkmcnt(2)
    v_mfma_f32_16x16x32_bf16 v[76:79], v[232:235], v[252:255], v[76:79]
    v_xor_b32 v4, 32, v2
    v_mfma_f32_16x16x32_bf16 v[72:75], v[204:207], v[252:255], v[72:75]
    v_xor_b32 v6, 0x4000, v2
    v_mfma_f32_16x16x32_bf16 v[68:71], v[244:247], v[252:255], v[68:71]
    v_xor_b32 v8, 0x4000, v4
    s_waitcnt lgkmcnt(0)
    v_mfma_f32_16x16x32_bf16 v[80:83], v[180:183], v[252:255], v[80:83]
    v_add_u32 v3, 0x10000, v2
    v_mfma_f32_16x16x32_bf16 v[64:67], v[180:183], v[176:179], v[64:67]
    v_add_u32 v5, 0x10000, v4
    v_mfma_f32_16x16x32_bf16 v[48:51], v[180:183], v[184:187], v[48:51]
    v_add_u32 v7, 0x10000, v6
    v_mfma_f32_16x16x32_bf16 v[32:35], v[180:183], v[228:231], v[32:35]
    v_add_u32 v9, 0x10000, v8
    v_pk_fma_f32 v[172:173], v[52:53], s[48:49], v[148:149]
    v_pk_fma_f32 v[174:175], v[54:55], s[48:49], v[150:151]
    v_exp_f32 v52, v172
    v_exp_f32 v53, v173
    v_exp_f32 v54, v174
    v_exp_f32 v55, v175
    v_pk_fma_f32 v[176:177], v[56:57], s[48:49], v[152:153]
    v_pk_fma_f32 v[178:179], v[58:59], s[48:49], v[154:155]
    v_pk_fma_f32 v[52:53], v[52:53], s[50:51], s[50:51]
    v_pk_fma_f32 v[54:55], v[54:55], s[50:51], s[50:51]
    v_exp_f32 v56, v176
    v_exp_f32 v57, v177
    v_exp_f32 v58, v178
    v_exp_f32 v59, v179
    v_pk_fma_f32 v[180:181], v[68:69], s[48:49], v[148:149]
    v_pk_fma_f32 v[182:183], v[70:71], s[48:49], v[150:151]
    v_rcp_f32 v52, v52
    v_rcp_f32 v53, v53
    v_rcp_f32 v54, v54
    v_rcp_f32 v55, v55
    v_pk_fma_f32 v[56:57], v[56:57], s[50:51], s[50:51]
    v_pk_fma_f32 v[58:59], v[58:59], s[50:51], s[50:51]
    v_exp_f32 v68, v180
    v_exp_f32 v69, v181
    v_exp_f32 v70, v182
    v_exp_f32 v71, v183
    v_pk_mul_f32 v[52:53], v[52:53], v[172:173]
    v_pk_mul_f32 v[54:55], v[54:55], v[174:175]
    v_pk_fma_f32 v[184:185], v[72:73], s[48:49], v[152:153]
    v_pk_fma_f32 v[186:187], v[74:75], s[48:49], v[154:155]
    v_rcp_f32 v56, v56
    v_rcp_f32 v57, v57
    v_rcp_f32 v58, v58
    v_rcp_f32 v59, v59
    v_pk_fma_f32 v[68:69], v[68:69], s[50:51], s[50:51]
    v_pk_fma_f32 v[70:71], v[70:71], s[50:51], s[50:51]
    v_cvt_pk_bf16_f32 v100, v52, v53
    v_cvt_pk_bf16_f32 v101, v54, v55
    v_exp_f32 v72, v184
    v_exp_f32 v73, v185
    v_exp_f32 v74, v186
    v_exp_f32 v75, v187
    v_pk_mul_f32 v[56:57], v[56:57], v[176:177]
    v_pk_mul_f32 v[58:59], v[58:59], v[178:179]
    v_pk_fma_f32 v[172:173], v[60:61], s[48:49], v[156:157]
    v_pk_fma_f32 v[174:175], v[62:63], s[48:49], v[158:159]
    v_rcp_f32 v68, v68
    v_rcp_f32 v69, v69
    v_rcp_f32 v70, v70
    v_rcp_f32 v71, v71
    v_pk_fma_f32 v[72:73], v[72:73], s[50:51], s[50:51]
    v_pk_fma_f32 v[74:75], v[74:75], s[50:51], s[50:51]
    v_cvt_pk_bf16_f32 v102, v56, v57
    v_cvt_pk_bf16_f32 v103, v58, v59
    v_exp_f32 v60, v172
    v_exp_f32 v61, v173
    v_exp_f32 v62, v174
    v_exp_f32 v63, v175
    buffer_store_dwordx4 v[100:103], v10, s[28:31], s54 offen offset:0 sc1
    ds_write_b128 v11, v[100:103] offset:0
    v_pk_mul_f32 v[68:69], v[68:69], v[180:181]
    v_pk_mul_f32 v[70:71], v[70:71], v[182:183]
    v_pk_fma_f32 v[176:177], v[64:65], s[48:49], v[160:161]
    v_pk_fma_f32 v[178:179], v[66:67], s[48:49], v[162:163]
    v_rcp_f32 v72, v72
    v_rcp_f32 v73, v73
    v_rcp_f32 v74, v74
    v_rcp_f32 v75, v75
    v_pk_fma_f32 v[60:61], v[60:61], s[50:51], s[50:51]
    v_pk_fma_f32 v[62:63], v[62:63], s[50:51], s[50:51]
    v_cvt_pk_bf16_f32 v108, v68, v69
    v_cvt_pk_bf16_f32 v109, v70, v71
    v_exp_f32 v64, v176
    v_exp_f32 v65, v177
    v_exp_f32 v66, v178
    v_exp_f32 v67, v179
    v_pk_mul_f32 v[72:73], v[72:73], v[184:185]
    v_pk_mul_f32 v[74:75], v[74:75], v[186:187]
    v_pk_fma_f32 v[180:181], v[76:77], s[48:49], v[156:157]
    v_pk_fma_f32 v[182:183], v[78:79], s[48:49], v[158:159]
    v_rcp_f32 v60, v60
    v_rcp_f32 v61, v61
    v_rcp_f32 v62, v62
    v_rcp_f32 v63, v63
    v_pk_fma_f32 v[64:65], v[64:65], s[50:51], s[50:51]
    v_pk_fma_f32 v[66:67], v[66:67], s[50:51], s[50:51]
    v_cvt_pk_bf16_f32 v110, v72, v73
    v_cvt_pk_bf16_f32 v111, v74, v75
    v_exp_f32 v76, v180
    v_exp_f32 v77, v181
    v_exp_f32 v78, v182
    v_exp_f32 v79, v183
    buffer_store_dwordx4 v[108:111], v10, s[28:31], s54 offen offset:256 sc1
    ds_write_b128 v11, v[108:111] offset:2048
    v_pk_mul_f32 v[60:61], v[60:61], v[172:173]
    v_pk_mul_f32 v[62:63], v[62:63], v[174:175]
    v_pk_fma_f32 v[184:185], v[80:81], s[48:49], v[160:161]
    v_pk_fma_f32 v[186:187], v[82:83], s[48:49], v[162:163]
    v_rcp_f32 v64, v64
    v_rcp_f32 v65, v65
    v_rcp_f32 v66, v66
    v_rcp_f32 v67, v67
    v_pk_fma_f32 v[76:77], v[76:77], s[50:51], s[50:51]
    v_pk_fma_f32 v[78:79], v[78:79], s[50:51], s[50:51]
    v_cvt_pk_bf16_f32 v104, v60, v61
    v_cvt_pk_bf16_f32 v105, v62, v63
    v_exp_f32 v80, v184
    v_exp_f32 v81, v185
    v_exp_f32 v82, v186
    v_exp_f32 v83, v187
    v_pk_mul_f32 v[64:65], v[64:65], v[176:177]
    v_pk_mul_f32 v[66:67], v[66:67], v[178:179]
    v_pk_fma_f32 v[172:173], v[20:21], s[48:49], v[148:149]
    v_pk_fma_f32 v[174:175], v[22:23], s[48:49], v[150:151]
    v_rcp_f32 v76, v76
    v_rcp_f32 v77, v77
    v_rcp_f32 v78, v78
    v_rcp_f32 v79, v79
    v_pk_fma_f32 v[80:81], v[80:81], s[50:51], s[50:51]
    v_pk_fma_f32 v[82:83], v[82:83], s[50:51], s[50:51]
    v_cvt_pk_bf16_f32 v106, v64, v65
    v_cvt_pk_bf16_f32 v107, v66, v67
    v_exp_f32 v20, v172
    v_exp_f32 v21, v173
    v_exp_f32 v22, v174
    v_exp_f32 v23, v175
    buffer_store_dwordx4 v[104:107], v10, s[28:31], s54 offen offset:512 sc1
    ds_write_b128 v11, v[104:107] offset:1024
    v_pk_mul_f32 v[76:77], v[76:77], v[180:181]
    v_pk_mul_f32 v[78:79], v[78:79], v[182:183]
    v_pk_fma_f32 v[176:177], v[24:25], s[48:49], v[152:153]
    v_pk_fma_f32 v[178:179], v[26:27], s[48:49], v[154:155]
    v_rcp_f32 v80, v80
    v_rcp_f32 v81, v81
    v_rcp_f32 v82, v82
    v_rcp_f32 v83, v83
    v_pk_fma_f32 v[20:21], v[20:21], s[50:51], s[50:51]
    v_pk_fma_f32 v[22:23], v[22:23], s[50:51], s[50:51]
    v_cvt_pk_bf16_f32 v112, v76, v77
    v_cvt_pk_bf16_f32 v113, v78, v79
    v_exp_f32 v24, v176
    v_exp_f32 v25, v177
    v_exp_f32 v26, v178
    v_exp_f32 v27, v179
    v_pk_mul_f32 v[80:81], v[80:81], v[184:185]
    v_pk_mul_f32 v[82:83], v[82:83], v[186:187]
    v_pk_fma_f32 v[180:181], v[36:37], s[48:49], v[148:149]
    v_pk_fma_f32 v[182:183], v[38:39], s[48:49], v[150:151]
    v_rcp_f32 v20, v20
    v_rcp_f32 v21, v21
    v_rcp_f32 v22, v22
    v_rcp_f32 v23, v23
    v_pk_fma_f32 v[24:25], v[24:25], s[50:51], s[50:51]
    v_pk_fma_f32 v[26:27], v[26:27], s[50:51], s[50:51]
    v_cvt_pk_bf16_f32 v114, v80, v81
    v_cvt_pk_bf16_f32 v115, v82, v83
    v_exp_f32 v36, v180
    v_exp_f32 v37, v181
    v_exp_f32 v38, v182
    v_exp_f32 v39, v183
    buffer_store_dwordx4 v[112:115], v10, s[28:31], s54 offen offset:768 sc1
    ds_write_b128 v11, v[112:115] offset:3072
    v_pk_mul_f32 v[20:21], v[20:21], v[172:173]
    v_pk_mul_f32 v[22:23], v[22:23], v[174:175]
    v_pk_fma_f32 v[184:185], v[40:41], s[48:49], v[152:153]
    v_pk_fma_f32 v[186:187], v[42:43], s[48:49], v[154:155]
    v_rcp_f32 v24, v24
    v_rcp_f32 v25, v25
    v_rcp_f32 v26, v26
    v_rcp_f32 v27, v27
    v_pk_fma_f32 v[36:37], v[36:37], s[50:51], s[50:51]
    v_pk_fma_f32 v[38:39], v[38:39], s[50:51], s[50:51]
    v_cvt_pk_bf16_f32 v84, v20, v21
    v_cvt_pk_bf16_f32 v85, v22, v23
    v_exp_f32 v40, v184
    v_exp_f32 v41, v185
    v_exp_f32 v42, v186
    v_exp_f32 v43, v187
    v_pk_mul_f32 v[24:25], v[24:25], v[176:177]
    v_pk_mul_f32 v[26:27], v[26:27], v[178:179]
    v_pk_fma_f32 v[172:173], v[28:29], s[48:49], v[156:157]
    v_pk_fma_f32 v[174:175], v[30:31], s[48:49], v[158:159]
    v_rcp_f32 v36, v36
    v_rcp_f32 v37, v37
    v_rcp_f32 v38, v38
    v_rcp_f32 v39, v39
    v_pk_fma_f32 v[40:41], v[40:41], s[50:51], s[50:51]
    v_pk_fma_f32 v[42:43], v[42:43], s[50:51], s[50:51]
    v_cvt_pk_bf16_f32 v86, v24, v25
    v_cvt_pk_bf16_f32 v87, v26, v27
    v_exp_f32 v28, v172
    v_exp_f32 v29, v173
    v_exp_f32 v30, v174
    v_exp_f32 v31, v175
    buffer_store_dwordx4 v[84:87], v10, s[28:31], s55 offen offset:0 sc1
    v_pk_mul_f32 v[36:37], v[36:37], v[180:181]
    v_pk_mul_f32 v[38:39], v[38:39], v[182:183]
    v_pk_fma_f32 v[176:177], v[32:33], s[48:49], v[160:161]
    v_pk_fma_f32 v[178:179], v[34:35], s[48:49], v[162:163]
    v_rcp_f32 v40, v40
    v_rcp_f32 v41, v41
    v_rcp_f32 v42, v42
    v_rcp_f32 v43, v43
    v_pk_fma_f32 v[28:29], v[28:29], s[50:51], s[50:51]
    v_pk_fma_f32 v[30:31], v[30:31], s[50:51], s[50:51]
    v_cvt_pk_bf16_f32 v92, v36, v37
    v_cvt_pk_bf16_f32 v93, v38, v39
    v_exp_f32 v32, v176
    v_exp_f32 v33, v177
    v_exp_f32 v34, v178
    v_exp_f32 v35, v179
    v_pk_mul_f32 v[40:41], v[40:41], v[184:185]
    v_pk_mul_f32 v[42:43], v[42:43], v[186:187]
    v_pk_fma_f32 v[180:181], v[44:45], s[48:49], v[156:157]
    v_pk_fma_f32 v[182:183], v[46:47], s[48:49], v[158:159]
    v_rcp_f32 v28, v28
    v_rcp_f32 v29, v29
    v_rcp_f32 v30, v30
    v_rcp_f32 v31, v31
    v_pk_fma_f32 v[32:33], v[32:33], s[50:51], s[50:51]
    v_pk_fma_f32 v[34:35], v[34:35], s[50:51], s[50:51]
    v_cvt_pk_bf16_f32 v94, v40, v41
    v_cvt_pk_bf16_f32 v95, v42, v43
    s_waitcnt lgkmcnt(0)
    s_barrier
    s_nop 0
    ds_read_b128 v[100:103], v13 offset:0
    ds_read_b128 v[108:111], v13 offset:2048
    ds_read_b128 v[104:107], v13 offset:1024
    ds_read_b128 v[112:115], v13 offset:3072
    v_exp_f32 v44, v180
    v_exp_f32 v45, v181
    v_exp_f32 v46, v182
    v_exp_f32 v47, v183
    buffer_store_dwordx4 v[92:95], v10, s[28:31], s55 offen offset:256 sc1
    v_pk_mul_f32 v[28:29], v[28:29], v[172:173]
    v_pk_mul_f32 v[30:31], v[30:31], v[174:175]
    v_pk_fma_f32 v[184:185], v[48:49], s[48:49], v[160:161]
    v_pk_fma_f32 v[186:187], v[50:51], s[48:49], v[162:163]
    v_rcp_f32 v32, v32
    v_rcp_f32 v33, v33
    v_rcp_f32 v34, v34
    v_rcp_f32 v35, v35
    v_pk_fma_f32 v[44:45], v[44:45], s[50:51], s[50:51]
    v_pk_fma_f32 v[46:47], v[46:47], s[50:51], s[50:51]
    v_cvt_pk_bf16_f32 v88, v28, v29
    v_cvt_pk_bf16_f32 v89, v30, v31
    v_exp_f32 v48, v184
    v_exp_f32 v49, v185
    v_exp_f32 v50, v186
    v_exp_f32 v51, v187
    v_pk_mul_f32 v[32:33], v[32:33], v[176:177]
    v_pk_mul_f32 v[34:35], v[34:35], v[178:179]
    v_rcp_f32 v44, v44
    v_rcp_f32 v45, v45
    v_rcp_f32 v46, v46
    v_rcp_f32 v47, v47
    v_pk_fma_f32 v[48:49], v[48:49], s[50:51], s[50:51]
    v_pk_fma_f32 v[50:51], v[50:51], s[50:51], s[50:51]
    v_cvt_pk_bf16_f32 v90, v32, v33
    v_cvt_pk_bf16_f32 v91, v34, v35
    buffer_store_dwordx4 v[88:91], v10, s[28:31], s55 offen offset:512 sc1
    v_pk_mul_f32 v[44:45], v[44:45], v[180:181]
    v_pk_mul_f32 v[46:47], v[46:47], v[182:183]
    v_rcp_f32 v48, v48
    v_rcp_f32 v49, v49
    v_rcp_f32 v50, v50
    v_rcp_f32 v51, v51
    v_cvt_pk_bf16_f32 v96, v44, v45
    v_cvt_pk_bf16_f32 v97, v46, v47
    s_waitcnt vmcnt(3)
    v_mov_b32 v15, 2
    buffer_store_dword v15, v12, s[28:31], 0 offen offset:256
    v_pk_mul_f32 v[48:49], v[48:49], v[184:185]
    v_pk_mul_f32 v[50:51], v[50:51], v[186:187]
    v_cvt_pk_bf16_f32 v98, v48, v49
    v_cvt_pk_bf16_f32 v99, v50, v51
    buffer_store_dwordx4 v[96:99], v10, s[28:31], s55 offen offset:768 sc1
    s_cmp_lg_u32 s66, 0
    s_cbranch_scc1 L_slow
L_slow_done:
    v_mfma_f32_16x16x32_bf16 v[20:23], v[116:119], v[166:169], 0
    v_mfma_f32_16x16x32_bf16 v[24:27], v[120:123], v[166:169], 0
    v_mfma_f32_16x16x32_bf16 v[36:39], v[124:127], v[166:169], 0
    v_mfma_f32_16x16x32_bf16 v[40:43], v[128:131], v[166:169], 0
    v_mfma_f32_16x16x32_bf16 v[52:55], v[132:135], v[166:169], 0
    v_mfma_f32_16x16x32_bf16 v[56:59], v[136:139], v[166:169], 0
    v_mfma_f32_16x16x32_bf16 v[68:71], v[140:143], v[166:169], 0
    v_mfma_f32_16x16x32_bf16 v[72:75], v[144:147], v[166:169], 0
    ds_read_b64_tr_b16 v[180:181], v6 offset:0
    v_mfma_f32_16x16x32_bf16 v[28:31], v[116:119], v[164:167], 0
    ds_read_b64_tr_b16 v[182:183], v6 offset:4096
    v_mfma_f32_16x16x32_bf16 v[32:35], v[120:123], v[164:167], 0
    ds_read_b64_tr_b16 v[184:185], v8 offset:0
    v_mfma_f32_16x16x32_bf16 v[44:47], v[124:127], v[164:167], 0
    ds_read_b64_tr_b16 v[186:187], v8 offset:4096
    v_mfma_f32_16x16x32_bf16 v[48:51], v[128:131], v[164:167], 0
    ds_read_b64_tr_b16 v[188:189], v6 offset:256
    v_mfma_f32_16x16x32_bf16 v[60:63], v[132:135], v[164:167], 0
    ds_read_b64_tr_b16 v[190:191], v6 offset:4352
    v_mfma_f32_16x16x32_bf16 v[64:67], v[136:139], v[164:167], 0
    ds_read_b64_tr_b16 v[192:193], v8 offset:256
    v_mfma_f32_16x16x32_bf16 v[76:79], v[140:143], v[164:167], 0
    ds_read_b64_tr_b16 v[194:195], v8 offset:4352
    v_mfma_f32_16x16x32_bf16 v[80:83], v[144:147], v[164:167], 0
    ds_read_b64_tr_b16 v[196:197], v6 offset:512
    s_waitcnt lgkmcnt(5)
    v_mfma_f32_16x16x32_bf16 v[20:23], v[100:103], v[180:183], v[20:23]
    ds_read_b64_tr_b16 v[198:199], v6 offset:4608
    v_mfma_f32_16x16x32_bf16 v[24:27], v[108:111], v[180:183], v[24:27]
    ds_read_b64_tr_b16 v[200:201], v8 offset:512
    v_mfma_f32_16x16x32_bf16 v[32:35], v[108:111], v[184:187], v[32:35]
    ds_read_b64_tr_b16 v[202:203], v8 offset:4608
    v_mfma_f32_16x16x32_bf16 v[28:31], v[100:103], v[184:187], v[28:31]
    ds_read_b64_tr_b16 v[204:205], v6 offset:768
    s_waitcnt lgkmcnt(5)
    v_mfma_f32_16x16x32_bf16 v[36:39], v[100:103], v[188:191], v[36:39]
    ds_read_b64_tr_b16 v[206:207], v6 offset:4864
    v_mfma_f32_16x16x32_bf16 v[40:43], v[108:111], v[188:191], v[40:43]
    ds_read_b64_tr_b16 v[180:181], v8 offset:768
    v_mfma_f32_16x16x32_bf16 v[48:51], v[108:111], v[192:195], v[48:51]
    ds_read_b64_tr_b16 v[182:183], v8 offset:4864
    v_mfma_f32_16x16x32_bf16 v[44:47], v[100:103], v[192:195], v[44:47]
    ds_read_b64_tr_b16 v[184:185], v6 offset:8192
    s_waitcnt lgkmcnt(5)
    v_mfma_f32_16x16x32_bf16 v[52:55], v[100:103], v[196:199], v[52:55]
    ds_read_b64_tr_b16 v[186:187], v6 offset:12288
    v_mfma_f32_16x16x32_bf16 v[56:59], v[108:111], v[196:199], v[56:59]
    ds_read_b64_tr_b16 v[188:189], v8 offset:8192
    v_mfma_f32_16x16x32_bf16 v[64:67], v[108:111], v[200:203], v[64:67]
    ds_read_b64_tr_b16 v[190:191], v8 offset:12288
    v_mfma_f32_16x16x32_bf16 v[60:63], v[100:103], v[200:203], v[60:63]
    ds_read_b64_tr_b16 v[192:193], v6 offset:8448
    s_waitcnt lgkmcnt(5)
    v_mfma_f32_16x16x32_bf16 v[68:71], v[100:103], v[204:207], v[68:71]
    ds_read_b64_tr_b16 v[194:195], v6 offset:12544
    v_mfma_f32_16x16x32_bf16 v[72:75], v[108:111], v[204:207], v[72:75]
    ds_read_b64_tr_b16 v[196:197], v8 offset:8448
    v_mfma_f32_16x16x32_bf16 v[80:83], v[108:111], v[180:183], v[80:83]
    ds_read_b64_tr_b16 v[198:199], v8 offset:12544
    v_mfma_f32_16x16x32_bf16 v[76:79], v[100:103], v[180:183], v[76:79]
    ds_read_b64_tr_b16 v[200:201], v6 offset:8704
    s_waitcnt lgkmcnt(5)
    v_mfma_f32_16x16x32_bf16 v[20:23], v[104:107], v[184:187], v[20:23]
    ds_read_b64_tr_b16 v[202:203], v6 offset:12800
    v_mfma_f32_16x16x32_bf16 v[24:27], v[112:115], v[184:187], v[24:27]
    ds_read_b64_tr_b16 v[204:205], v8 offset:8704
    v_mfma_f32_16x16x32_bf16 v[32:35], v[112:115], v[188:191], v[32:35]
    ds_read_b64_tr_b16 v[206:207], v8 offset:12800
    v_mfma_f32_16x16x32_bf16 v[28:31], v[104:107], v[188:191], v[28:31]
    ds_read_b64_tr_b16 v[180:181], v6 offset:8960
    s_waitcnt lgkmcnt(5)
    v_mfma_f32_16x16x32_bf16 v[36:39], v[104:107], v[192:195], v[36:39]
    ds_read_b64_tr_b16 v[182:183], v6 offset:13056
    v_mfma_f32_16x16x32_bf16 v[40:43], v[112:115], v[192:195], v[40:43]
    ds_read_b64_tr_b16 v[184:185], v8 offset:8960
    v_mfma_f32_16x16x32_bf16 v[48:51], v[112:115], v[196:199], v[48:51]
    ds_read_b64_tr_b16 v[186:187], v8 offset:13056
    v_mfma_f32_16x16x32_bf16 v[44:47], v[104:107], v[196:199], v[44:47]
    ds_read_b64_tr_b16 v[188:189], v2 offset:0
    s_waitcnt lgkmcnt(5)
    v_mfma_f32_16x16x32_bf16 v[52:55], v[104:107], v[200:203], v[52:55]
    ds_read_b64_tr_b16 v[190:191], v2 offset:4096
    v_mfma_f32_16x16x32_bf16 v[56:59], v[112:115], v[200:203], v[56:59]
    ds_read_b64_tr_b16 v[192:193], v4 offset:0
    v_mfma_f32_16x16x32_bf16 v[64:67], v[112:115], v[204:207], v[64:67]
    ds_read_b64_tr_b16 v[194:195], v4 offset:4096
    s_waitcnt vmcnt(0)
    v_mov_b32 v15, 4
    buffer_store_dword v15, v12, s[28:31], 0 offen offset:256
    v_mfma_f32_16x16x32_bf16 v[60:63], v[104:107], v[204:207], v[60:63]
    ds_read_b64_tr_b16 v[196:197], v2 offset:256
    s_waitcnt lgkmcnt(5)
    v_mfma_f32_16x16x32_bf16 v[68:71], v[104:107], v[180:183], v[68:71]
    ds_read_b64_tr_b16 v[198:199], v2 offset:4352
    v_mfma_f32_16x16x32_bf16 v[72:75], v[112:115], v[180:183], v[72:75]
    ds_read_b64_tr_b16 v[200:201], v4 offset:256
    v_mfma_f32_16x16x32_bf16 v[80:83], v[112:115], v[184:187], v[80:83]
    ds_read_b64_tr_b16 v[202:203], v4 offset:4352
    v_mfma_f32_16x16x32_bf16 v[76:79], v[104:107], v[184:187], v[76:79]
    ds_read_b64_tr_b16 v[204:205], v2 offset:512
    s_waitcnt lgkmcnt(5)
    v_mfma_f32_16x16x32_bf16 v[20:23], v[84:87], v[188:191], v[20:23]
    ds_read_b64_tr_b16 v[206:207], v2 offset:4608
    v_mfma_f32_16x16x32_bf16 v[24:27], v[92:95], v[188:191], v[24:27]
    ds_read_b64_tr_b16 v[180:181], v4 offset:512
    ds_read_b32 v14, v19
    v_mfma_f32_16x16x32_bf16 v[32:35], v[92:95], v[192:195], v[32:35]
    ds_read_b64_tr_b16 v[182:183], v4 offset:4608
    v_mfma_f32_16x16x32_bf16 v[28:31], v[84:87], v[192:195], v[28:31]
    ds_read_b64_tr_b16 v[184:185], v2 offset:768
    s_waitcnt lgkmcnt(6)
    v_mfma_f32_16x16x32_bf16 v[36:39], v[84:87], v[196:199], v[36:39]
    ds_read_b64_tr_b16 v[186:187], v2 offset:4864
    v_mfma_f32_16x16x32_bf16 v[40:43], v[92:95], v[196:199], v[40:43]
    ds_read_b64_tr_b16 v[188:189], v4 offset:768
    v_mfma_f32_16x16x32_bf16 v[48:51], v[92:95], v[200:203], v[48:51]
    ds_read_b64_tr_b16 v[190:191], v4 offset:4864
    v_mfma_f32_16x16x32_bf16 v[44:47], v[84:87], v[200:203], v[44:47]
    ds_read_b64_tr_b16 v[192:193], v2 offset:8192
    s_waitcnt lgkmcnt(6)
    v_readfirstlane_b32 s45, v14
    v_mfma_f32_16x16x32_bf16 v[52:55], v[84:87], v[204:207], v[52:55]
    ds_read_b64_tr_b16 v[194:195], v2 offset:12288
    s_cmp_ge_u32 s45, 2
    s_cbranch_scc0 L_spin0
L_back0:
    buffer_load_dwordx4 v[208:211], v10, s[28:31], s56 offen offset:0 sc1
    v_mfma_f32_16x16x32_bf16 v[56:59], v[92:95], v[204:207], v[56:59]
    ds_read_b64_tr_b16 v[196:197], v4 offset:8192
    s_waitcnt lgkmcnt(5)
    v_mfma_f32_16x16x32_bf16 v[64:67], v[92:95], v[180:183], v[64:67]
    ds_read_b64_tr_b16 v[198:199], v4 offset:12288
    v_mfma_f32_16x16x32_bf16 v[60:63], v[84:87], v[180:183], v[60:63]
    ds_read_b64_tr_b16 v[200:201], v2 offset:8448
    ds_read_b128 v[176:179], v19 offset:16
    v_mfma_f32_16x16x32_bf16 v[68:71], v[84:87], v[184:187], v[68:71]
    ds_read_b64_tr_b16 v[202:203], v2 offset:12544
    v_mfma_f32_16x16x32_bf16 v[72:75], v[92:95], v[184:187], v[72:75]
    ds_read_b64_tr_b16 v[204:205], v4 offset:8448
    buffer_load_dwordx4 v[212:215], v10, s[28:31], s56 offen offset:256 sc1
    s_waitcnt lgkmcnt(6)
    v_mfma_f32_16x16x32_bf16 v[80:83], v[92:95], v[188:191], v[80:83]
    ds_read_b64_tr_b16 v[206:207], v4 offset:12544
    v_mfma_f32_16x16x32_bf16 v[76:79], v[84:87], v[188:191], v[76:79]
    ds_read_b64_tr_b16 v[180:181], v2 offset:8704
    v_mfma_f32_16x16x32_bf16 v[20:23], v[88:91], v[192:195], v[20:23]
    ds_read_b64_tr_b16 v[182:183], v2 offset:12800
    v_mfma_f32_16x16x32_bf16 v[24:27], v[96:99], v[192:195], v[24:27]
    ds_read_b64_tr_b16 v[184:185], v4 offset:8704
    s_waitcnt lgkmcnt(5)
    v_mfma_f32_16x16x32_bf16 v[32:35], v[96:99], v[196:199], v[32:35]
    ds_read_b64_tr_b16 v[186:187], v4 offset:12800
    buffer_load_dwordx4 v[216:219], v10, s[28:31], s58 offen offset:0 sc1
    v_min3_u32 v14, v176, v177, v178
    v_mfma_f32_16x16x32_bf16 v[28:31], v[88:91], v[196:199], v[28:31]
    ds_read_b64_tr_b16 v[188:189], v2 offset:8960
    v_min_u32 v14, v14, v179
    v_mfma_f32_16x16x32_bf16 v[36:39], v[88:91], v[200:203], v[36:39]
    ds_read_b64_tr_b16 v[190:191], v2 offset:13056
    v_readfirstlane_b32 s45, v14
    v_mfma_f32_16x16x32_bf16 v[40:43], v[96:99], v[200:203], v[40:43]
    ds_read_b64_tr_b16 v[192:193], v4 offset:8960
    s_cmp_ge_u32 s45, 1
    s_cbranch_scc0 L_spinW
L_backW:
    s_waitcnt lgkmcnt(5)
    v_mfma_f32_16x16x32_bf16 v[48:51], v[96:99], v[204:207], v[48:51]
    ds_read_b64_tr_b16 v[194:195], v4 offset:13056
    v_mfma_f32_16x16x32_bf16 v[44:47], v[88:91], v[204:207], v[44:47]
    ds_read_b64_tr_b16 v[196:197], v6 offset:32768
    buffer_load_dwordx4 v[220:223], v10, s[28:31], s58 offen offset:256 sc1
    v_mfma_f32_16x16x32_bf16 v[52:55], v[88:91], v[180:183], v[52:55]
    ds_read_b64_tr_b16 v[198:199], v6 offset:36864
    v_mfma_f32_16x16x32_bf16 v[56:59], v[96:99], v[180:183], v[56:59]
    ds_read_b64_tr_b16 v[200:201], v8 offset:32768
    s_waitcnt lgkmcnt(5)
    v_mfma_f32_16x16x32_bf16 v[64:67], v[96:99], v[184:187], v[64:67]
    ds_read_b64_tr_b16 v[202:203], v8 offset:36864
    v_mfma_f32_16x16x32_bf16 v[60:63], v[88:91], v[184:187], v[60:63]
    ds_read_b64_tr_b16 v[204:205], v6 offset:33024
    v_mfma_f32_16x16x32_bf16 v[68:71], v[88:91], v[188:191], v[68:71]
    ds_read_b64_tr_b16 v[206:207], v6 offset:37120
    buffer_load_dwordx4 v[224:227], v10, s[28:31], s60 offen offset:0 sc1
    v_mfma_f32_16x16x32_bf16 v[72:75], v[96:99], v[188:191], v[72:75]
    ds_read_b64_tr_b16 v[180:181], v8 offset:33024
    s_waitcnt lgkmcnt(5)
    v_mfma_f32_16x16x32_bf16 v[80:83], v[96:99], v[192:195], v[80:83]
    ds_read_b64_tr_b16 v[182:183], v8 offset:37120
    v_mfma_f32_16x16x32_bf16 v[76:79], v[88:91], v[192:195], v[76:79]
    ds_read_b64_tr_b16 v[184:185], v6 offset:33280
    s_waitcnt vmcnt(4)
    v_mfma_f32_16x16x32_bf16 v[20:23], v[208:211], v[196:199], v[20:23]
    ds_read_b64_tr_b16 v[186:187], v6 offset:37376
    s_waitcnt vmcnt(3)
    v_mfma_f32_16x16x32_bf16 v[24:27], v[212:215], v[196:199], v[24:27]
    ds_read_b64_tr_b16 v[188:189], v8 offset:33280
    buffer_load_dwordx4 v[228:231], v10, s[28:31], s60 offen offset:256 sc1
    s_waitcnt lgkmcnt(5)
    v_mfma_f32_16x16x32_bf16 v[32:35], v[212:215], v[200:203], v[32:35]
    ds_read_b64_tr_b16 v[190:191], v8 offset:37376
    v_mfma_f32_16x16x32_bf16 v[28:31], v[208:211], v[200:203], v[28:31]
    ds_read_b64_tr_b16 v[192:193], v6 offset:33536
    v_mfma_f32_16x16x32_bf16 v[36:39], v[208:211], v[204:207], v[36:39]
    ds_read_b64_tr_b16 v[194:195], v6 offset:37632
    v_mfma_f32_16x16x32_bf16 v[40:43], v[212:215], v[204:207], v[40:43]
    ds_read_b64_tr_b16 v[196:197], v8 offset:33536
    s_waitcnt lgkmcnt(5)
    v_mfma_f32_16x16x32_bf16 v[48:51], v[212:215], v[180:183], v[48:51]
    ds_read_b64_tr_b16 v[198:199], v8 offset:37632
    buffer_load_dwordx4 v[232:235], v10, s[28:31], s56 offen offset:512 sc1
    v_mfma_f32_16x16x32_bf16 v[44:47], v[208:211], v[180:183], v[44:47]
    ds_read_b64_tr_b16 v[200:201], v7 offset:0
    v_mfma_f32_16x16x32_bf16 v[52:55], v[208:211], v[184:187], v[52:55]
    ds_read_b64_tr_b16 v[202:203], v7 offset:4096
    v_mfma_f32_16x16x32_bf16 v[56:59], v[212:215], v[184:187], v[56:59]
    ds_read_b64_tr_b16 v[204:205], v9 offset:0
    s_waitcnt lgkmcnt(5)
    v_mfma_f32_16x16x32_bf16 v[64:67], v[212:215], v[188:191], v[64:67]
    ds_read_b64_tr_b16 v[206:207], v9 offset:4096
    v_mfma_f32_16x16x32_bf16 v[60:63], v[208:211], v[188:191], v[60:63]
    ds_read_b64_tr_b16 v[180:181], v7 offset:256
    buffer_load_dwordx4 v[236:239], v10, s[28:31], s56 offen offset:768 sc1
    v_mfma_f32_16x16x32_bf16 v[68:71], v[208:211], v[192:195], v[68:71]
    ds_read_b64_tr_b16 v[182:183], v7 offset:4352
    v_mfma_f32_16x16x32_bf16 v[72:75], v[212:215], v[192:195], v[72:75]
    ds_read_b64_tr_b16 v[184:185], v9 offset:256
    s_waitcnt lgkmcnt(5)
    v_mfma_f32_16x16x32_bf16 v[80:83], v[212:215], v[196:199], v[80:83]
    ds_read_b64_tr_b16 v[186:187], v9 offset:4352
    v_mfma_f32_16x16x32_bf16 v[76:79], v[208:211], v[196:199], v[76:79]
    ds_read_b64_tr_b16 v[188:189], v7 offset:512
    s_waitcnt vmcnt(5)
    v_mfma_f32_16x16x32_bf16 v[20:23], v[216:219], v[200:203], v[20:23]
    ds_read_b64_tr_b16 v[190:191], v7 offset:4608
    buffer_load_dwordx4 v[240:243], v10, s[28:31], s58 offen offset:512 sc1
    s_waitcnt vmcnt(5)
    v_mfma_f32_16x16x32_bf16 v[24:27], v[220:223], v[200:203], v[24:27]
    ds_read_b64_tr_b16 v[192:193], v9 offset:512
    s_waitcnt lgkmcnt(5)
    v_mfma_f32_16x16x32_bf16 v[32:35], v[220:223], v[204:207], v[32:35]
    ds_read_b64_tr_b16 v[194:195], v9 offset:4608
    v_mfma_f32_16x16x32_bf16 v[28:31], v[216:219], v[204:207], v[28:31]
    ds_read_b64_tr_b16 v[196:197], v7 offset:768
    v_mfma_f32_16x16x32_bf16 v[36:39], v[216:219], v[180:183], v[36:39]
    ds_read_b64_tr_b16 v[198:199], v7 offset:4864
    v_mfma_f32_16x16x32_bf16 v[40:43], v[220:223], v[180:183], v[40:43]
    ds_read_b64_tr_b16 v[200:201], v9 offset:768
    buffer_load_dwordx4 v[244:247], v10, s[28:31], s58 offen offset:768 sc1
    s_waitcnt lgkmcnt(5)
    v_mfma_f32_16x16x32_bf16 v[48:51], v[220:223], v[184:187], v[48:51]
    ds_read_b64_tr_b16 v[202:203], v9 offset:4864
    v_mfma_f32_16x16x32_bf16 v[44:47], v[216:219], v[184:187], v[44:47]
    ds_read_b64_tr_b16 v[204:205], v7 offset:32768
    v_mfma_f32_16x16x32_bf16 v[52:55], v[216:219], v[188:191], v[52:55]
    ds_read_b64_tr_b16 v[206:207], v7 offset:36864
    v_mfma_f32_16x16x32_bf16 v[56:59], v[220:223], v[188:191], v[56:59]
    ds_read_b64_tr_b16 v[180:181], v9 offset:32768
    s_waitcnt lgkmcnt(5)
    v_mfma_f32_16x16x32_bf16 v[64:67], v[220:223], v[192:195], v[64:67]
    ds_read_b64_tr_b16 v[182:183], v9 offset:36864
    buffer_load_dwordx4 v[248:251], v10, s[28:31], s60 offen offset:512 sc1
    v_mfma_f32_16x16x32_bf16 v[60:63], v[216:219], v[192:195], v[60:63]
    ds_read_b64_tr_b16 v[184:185], v7 offset:33024
    v_mfma_f32_16x16x32_bf16 v[68:71], v[216:219], v[196:199], v[68:71]
    ds_read_b64_tr_b16 v[186:187], v7 offset:37120
    v_mfma_f32_16x16x32_bf16 v[72:75], v[220:223], v[196:199], v[72:75]
    ds_read_b64_tr_b16 v[188:189], v9 offset:33024
    ds_read_b32 v14, v19
    s_waitcnt lgkmcnt(6)
    v_mfma_f32_16x16x32_bf16 v[80:83], v[220:223], v[200:203], v[80:83]
    ds_read_b64_tr_b16 v[190:191], v9 offset:37120
    v_mfma_f32_16x16x32_bf16 v[76:79], v[216:219], v[200:203], v[76:79]
    ds_read_b64_tr_b16 v[192:193], v7 offset:33280
    buffer_load_dwordx4 v[252:255], v10, s[28:31], s60 offen offset:768 sc1
    s_waitcnt vmcnt(7)
    v_mfma_f32_16x16x32_bf16 v[20:23], v[224:227], v[204:207], v[20:23]
    ds_read_b64_tr_b16 v[194:195], v7 offset:37376
    s_waitcnt vmcnt(6)
    v_mfma_f32_16x16x32_bf16 v[24:27], v[228:231], v[204:207], v[24:27]
    ds_read_b64_tr_b16 v[196:197], v9 offset:33280
    s_waitcnt lgkmcnt(6)
    v_mfma_f32_16x16x32_bf16 v[32:35], v[228:231], v[180:183], v[32:35]
    ds_read_b64_tr_b16 v[198:199], v9 offset:37376
    v_mfma_f32_16x16x32_bf16 v[28:31], v[224:227], v[180:183], v[28:31]
    ds_read_b64_tr_b16 v[200:201], v7 offset:33536
    s_waitcnt lgkmcnt(6)
    v_readfirstlane_b32 s45, v14
    v_mfma_f32_16x16x32_bf16 v[36:39], v[224:227], v[184:187], v[36:39]
    ds_read_b64_tr_b16 v[202:203], v7 offset:37632
    s_cmp_ge_u32 s45, 4
    s_cbranch_scc0 L_spin2
L_back2:
    buffer_load_dwordx4 v[148:151], v10, s[28:31], s57 offen offset:0 sc1
    v_mfma_f32_16x16x32_bf16 v[40:43], v[228:231], v[184:187], v[40:43]
    ds_read_b64_tr_b16 v[204:205], v9 offset:33536
    s_waitcnt lgkmcnt(5)
    v_mfma_f32_16x16x32_bf16 v[48:51], v[228:231], v[188:191], v[48:51]
    ds_read_b64_tr_b16 v[206:207], v9 offset:37632
    v_mfma_f32_16x16x32_bf16 v[44:47], v[224:227], v[188:191], v[44:47]
    ds_read_b64_tr_b16 v[180:181], v6 offset:40960
    buffer_load_dwordx4 v[152:155], v10, s[28:31], s57 offen offset:256 sc1
    v_mfma_f32_16x16x32_bf16 v[52:55], v[224:227], v[192:195], v[52:55]
    ds_read_b64_tr_b16 v[182:183], v6 offset:45056
    v_mfma_f32_16x16x32_bf16 v[56:59], v[228:231], v[192:195], v[56:59]
    ds_read_b64_tr_b16 v[184:185], v8 offset:40960
    s_waitcnt lgkmcnt(5)
    v_mfma_f32_16x16x32_bf16 v[64:67], v[228:231], v[196:199], v[64:67]
    ds_read_b64_tr_b16 v[186:187], v8 offset:45056
    buffer_load_dwordx4 v[156:159], v10, s[28:31], s59 offen offset:0 sc1
    v_mfma_f32_16x16x32_bf16 v[60:63], v[224:227], v[196:199], v[60:63]
    ds_read_b64_tr_b16 v[188:189], v6 offset:41216
    v_mfma_f32_16x16x32_bf16 v[68:71], v[224:227], v[200:203], v[68:71]
    ds_read_b64_tr_b16 v[190:191], v6 offset:45312
    v_mfma_f32_16x16x32_bf16 v[72:75], v[228:231], v[200:203], v[72:75]
    ds_read_b64_tr_b16 v[192:193], v8 offset:41216
    buffer_load_dwordx4 v[160:163], v10, s[28:31], s59 offen offset:256 sc1
    s_waitcnt lgkmcnt(5)
    v_mfma_f32_16x16x32_bf16 v[80:83], v[228:231], v[204:207], v[80:83]
    ds_read_b64_tr_b16 v[194:195], v8 offset:45312
    v_mfma_f32_16x16x32_bf16 v[76:79], v[224:227], v[204:207], v[76:79]
    ds_read_b64_tr_b16 v[196:197], v6 offset:41472
    s_waitcnt vmcnt(9)
    v_mfma_f32_16x16x32_bf16 v[20:23], v[232:235], v[180:183], v[20:23]
    ds_read_b64_tr_b16 v[198:199], v6 offset:45568
    buffer_load_dwordx4 v[116:119], v10, s[28:31], s61 offen offset:0 sc1
    s_waitcnt vmcnt(9)
    v_mfma_f32_16x16x32_bf16 v[24:27], v[236:239], v[180:183], v[24:27]
    ds_read_b64_tr_b16 v[200:201], v8 offset:41472
    s_waitcnt lgkmcnt(5)
    v_mfma_f32_16x16x32_bf16 v[32:35], v[236:239], v[184:187], v[32:35]
    ds_read_b64_tr_b16 v[202:203], v8 offset:45568
    v_mfma_f32_16x16x32_bf16 v[28:31], v[232:235], v[184:187], v[28:31]
    ds_read_b64_tr_b16 v[204:205], v6 offset:41728
    buffer_load_dwordx4 v[120:123], v10, s[28:31], s61 offen offset:256 sc1
    v_mfma_f32_16x16x32_bf16 v[36:39], v[232:235], v[188:191], v[36:39]
    ds_read_b64_tr_b16 v[206:207], v6 offset:45824
    v_mfma_f32_16x16x32_bf16 v[40:43], v[236:239], v[188:191], v[40:43]
    ds_read_b64_tr_b16 v[180:181], v8 offset:41728
    s_waitcnt lgkmcnt(5)
    v_mfma_f32_16x16x32_bf16 v[48:51], v[236:239], v[192:195], v[48:51]
    ds_read_b64_tr_b16 v[182:183], v8 offset:45824
    buffer_load_dwordx4 v[124:127], v10, s[28:31], s57 offen offset:512 sc1
    v_mfma_f32_16x16x32_bf16 v[44:47], v[232:235], v[192:195], v[44:47]
    ds_read_b64_tr_b16 v[184:185], v7 offset:8192
    v_mfma_f32_16x16x32_bf16 v[52:55], v[232:235], v[196:199], v[52:55]
    ds_read_b64_tr_b16 v[186:187], v7 offset:12288
    v_mfma_f32_16x16x32_bf16 v[56:59], v[236:239], v[196:199], v[56:59]
    ds_read_b64_tr_b16 v[188:189], v9 offset:8192
    buffer_load_dwordx4 v[128:131], v10, s[28:31], s57 offen offset:768 sc1
    s_waitcnt lgkmcnt(5)
    v_mfma_f32_16x16x32_bf16 v[64:67], v[236:239], v[200:203], v[64:67]
    ds_read_b64_tr_b16 v[190:191], v9 offset:12288
    v_mfma_f32_16x16x32_bf16 v[60:63], v[232:235], v[200:203], v[60:63]
    ds_read_b64_tr_b16 v[192:193], v7 offset:8448
    v_mfma_f32_16x16x32_bf16 v[68:71], v[232:235], v[204:207], v[68:71]
    ds_read_b64_tr_b16 v[194:195], v7 offset:12544
    buffer_load_dwordx4 v[132:135], v10, s[28:31], s59 offen offset:512 sc1
    v_mfma_f32_16x16x32_bf16 v[72:75], v[236:239], v[204:207], v[72:75]
    ds_read_b64_tr_b16 v[196:197], v9 offset:8448
    s_waitcnt lgkmcnt(5)
    v_mfma_f32_16x16x32_bf16 v[80:83], v[236:239], v[180:183], v[80:83]
    ds_read_b64_tr_b16 v[198:199], v9 offset:12544
    v_mfma_f32_16x16x32_bf16 v[76:79], v[232:235], v[180:183], v[76:79]
    ds_read_b64_tr_b16 v[200:201], v7 offset:8704
    buffer_load_dwordx4 v[136:139], v10, s[28:31], s59 offen offset:768 sc1
    s_waitcnt vmcnt(13)
    v_mfma_f32_16x16x32_bf16 v[20:23], v[240:243], v[184:187], v[20:23]
    ds_read_b64_tr_b16 v[202:203], v7 offset:12800
    s_waitcnt vmcnt(12)
    v_mfma_f32_16x16x32_bf16 v[24:27], v[244:247], v[184:187], v[24:27]
    ds_read_b64_tr_b16 v[204:205], v9 offset:8704
    s_waitcnt lgkmcnt(5)
    v_mfma_f32_16x16x32_bf16 v[32:35], v[244:247], v[188:191], v[32:35]
    ds_read_b64_tr_b16 v[206:207], v9 offset:12800
    buffer_load_dwordx4 v[140:143], v10, s[28:31], s61 offen offset:512 sc1
    v_mfma_f32_16x16x32_bf16 v[28:31], v[240:243], v[188:191], v[28:31]
    ds_read_b64_tr_b16 v[180:181], v7 offset:8960
    v_mfma_f32_16x16x32_bf16 v[36:39], v[240:243], v[192:195], v[36:39]
    ds_read_b64_tr_b16 v[182:183], v7 offset:13056
    v_mfma_f32_16x16x32_bf16 v[40:43], v[244:247], v[192:195], v[40:43]
    ds_read_b64_tr_b16 v[184:185], v9 offset:8960
    buffer_load_dwordx4 v[144:147], v10, s[28:31], s61 offen offset:768 sc1
    s_waitcnt lgkmcnt(5)
    v_mfma_f32_16x16x32_bf16 v[48:51], v[244:247], v[196:199], v[48:51]
    ds_read_b64_tr_b16 v[186:187], v9 offset:13056
    v_mfma_f32_16x16x32_bf16 v[44:47], v[240:243], v[196:199], v[44:47]
    ds_read_b64_tr_b16 v[188:189], v7 offset:40960
    v_mfma_f32_16x16x32_bf16 v[52:55], v[240:243], v[200:203], v[52:55]
    ds_read_b64_tr_b16 v[190:191], v7 offset:45056
    v_mfma_f32_16x16x32_bf16 v[56:59], v[244:247], v[200:203], v[56:59]
    ds_read_b64_tr_b16 v[192:193], v9 offset:40960
    s_waitcnt lgkmcnt(5)
    v_mfma_f32_16x16x32_bf16 v[64:67], v[244:247], v[204:207], v[64:67]
    ds_read_b64_tr_b16 v[194:195], v9 offset:45056
    v_mfma_f32_16x16x32_bf16 v[60:63], v[240:243], v[204:207], v[60:63]
    ds_read_b64_tr_b16 v[196:197], v7 offset:41216
    v_mfma_f32_16x16x32_bf16 v[68:71], v[240:243], v[180:183], v[68:71]
    ds_read_b64_tr_b16 v[198:199], v7 offset:45312
    s_lshl_b32 s44, s23, 28
    v_lshl_or_b32 v172, v0, 24, s44
    v_mfma_f32_16x16x32_bf16 v[72:75], v[244:247], v[180:183], v[72:75]
    ds_read_b64_tr_b16 v[200:201], v9 offset:41216
    s_waitcnt lgkmcnt(5)
    v_mov_b32 v173, s21
    v_mfma_f32_16x16x32_bf16 v[80:83], v[244:247], v[184:187], v[80:83]
    ds_read_b64_tr_b16 v[202:203], v9 offset:45312
    buffer_store_dword v173, v172, s[28:31], s20 offen sc1
    v_mfma_f32_16x16x32_bf16 v[76:79], v[240:243], v[184:187], v[76:79]
    ds_read_b64_tr_b16 v[204:205], v7 offset:41472
    s_waitcnt vmcnt(14)
    v_mfma_f32_16x16x32_bf16 v[20:23], v[248:251], v[188:191], v[20:23]
    ds_read_b64_tr_b16 v[206:207], v7 offset:45568
    s_waitcnt vmcnt(13)
    v_mfma_f32_16x16x32_bf16 v[24:27], v[252:255], v[188:191], v[24:27]
    ds_read_b64_tr_b16 v[180:181], v9 offset:41472
    s_waitcnt lgkmcnt(5)
    v_mfma_f32_16x16x32_bf16 v[32:35], v[252:255], v[192:195], v[32:35]
    ds_read_b64_tr_b16 v[182:183], v9 offset:45568
    v_mfma_f32_16x16x32_bf16 v[28:31], v[248:251], v[192:195], v[28:31]
    ds_read_b64_tr_b16 v[184:185], v7 offset:41728
    v_mfma_f32_16x16x32_bf16 v[36:39], v[248:251], v[196:199], v[36:39]
    ds_read_b64_tr_b16 v[186:187], v7 offset:45824
    v_mfma_f32_16x16x32_bf16 v[40:43], v[252:255], v[196:199], v[40:43]
    ds_read_b64_tr_b16 v[188:189], v9 offset:41728
    s_waitcnt lgkmcnt(5)
    v_mfma_f32_16x16x32_bf16 v[48:51], v[252:255], v[200:203], v[48:51]
    ds_read_b64_tr_b16 v[190:191], v9 offset:45824
    v_mfma_f32_16x16x32_bf16 v[44:47], v[248:251], v[200:203], v[44:47]
    ds_read_b64_tr_b16 v[192:193], v2 offset:32768
    v_mfma_f32_16x16x32_bf16 v[52:55], v[248:251], v[204:207], v[52:55]
    ds_read_b64_tr_b16 v[194:195], v2 offset:36864
    v_mfma_f32_16x16x32_bf16 v[56:59], v[252:255], v[204:207], v[56:59]
    ds_read_b64_tr_b16 v[196:197], v3 offset:0
    s_waitcnt lgkmcnt(5)
    v_mfma_f32_16x16x32_bf16 v[64:67], v[252:255], v[180:183], v[64:67]
    ds_read_b64_tr_b16 v[198:199], v3 offset:4096
    v_mfma_f32_16x16x32_bf16 v[60:63], v[248:251], v[180:183], v[60:63]
    ds_read_b64_tr_b16 v[200:201], v3 offset:32768
    v_mfma_f32_16x16x32_bf16 v[68:71], v[248:251], v[184:187], v[68:71]
    ds_read_b64_tr_b16 v[202:203], v3 offset:36864
    v_mfma_f32_16x16x32_bf16 v[72:75], v[252:255], v[184:187], v[72:75]
    ds_read_b64_tr_b16 v[204:205], v2 offset:40960
    s_waitcnt lgkmcnt(5)
    v_mfma_f32_16x16x32_bf16 v[80:83], v[252:255], v[188:191], v[80:83]
    ds_read_b64_tr_b16 v[206:207], v2 offset:45056
    v_mfma_f32_16x16x32_bf16 v[76:79], v[248:251], v[188:191], v[76:79]
    ds_read_b64_tr_b16 v[180:181], v3 offset:8192
    s_waitcnt vmcnt(12)
    v_mfma_f32_16x16x32_bf16 v[20:23], v[148:151], v[192:195], v[20:23]
    ds_read_b64_tr_b16 v[182:183], v3 offset:12288
    s_waitcnt vmcnt(11)
    v_mfma_f32_16x16x32_bf16 v[24:27], v[152:155], v[192:195], v[24:27]
    ds_read_b64_tr_b16 v[184:185], v3 offset:40960
    s_waitcnt vmcnt(10)
    s_waitcnt lgkmcnt(5)
    v_mfma_f32_16x16x32_bf16 v[20:23], v[156:159], v[196:199], v[20:23]
    ds_read_b64_tr_b16 v[186:187], v3 offset:45056
    s_waitcnt vmcnt(9)
    v_mfma_f32_16x16x32_bf16 v[24:27], v[160:163], v[196:199], v[24:27]
    ds_read_b64_tr_b16 v[188:189], v4 offset:32768
    s_waitcnt vmcnt(8)
    v_mfma_f32_16x16x32_bf16 v[20:23], v[116:119], v[200:203], v[20:23]
    ds_read_b64_tr_b16 v[190:191], v4 offset:36864
    s_waitcnt vmcnt(7)
    v_mfma_f32_16x16x32_bf16 v[24:27], v[120:123], v[200:203], v[24:27]
    ds_read_b64_tr_b16 v[192:193], v5 offset:0
    s_waitcnt vmcnt(6)
    s_waitcnt lgkmcnt(5)
    v_mfma_f32_16x16x32_bf16 v[20:23], v[124:127], v[204:207], v[20:23]
    ds_read_b64_tr_b16 v[194:195], v5 offset:4096
    s_waitcnt vmcnt(5)
    v_mfma_f32_16x16x32_bf16 v[24:27], v[128:131], v[204:207], v[24:27]
    ds_read_b64_tr_b16 v[196:197], v5 offset:32768
    s_waitcnt vmcnt(4)
    v_mfma_f32_16x16x32_bf16 v[20:23], v[132:135], v[180:183], v[20:23]
    ds_read_b64_tr_b16 v[198:199], v5 offset:36864
    s_waitcnt vmcnt(3)
    v_mfma_f32_16x16x32_bf16 v[24:27], v[136:139], v[180:183], v[24:27]
    ds_read_b64_tr_b16 v[200:201], v4 offset:40960
    s_waitcnt vmcnt(2)
    s_waitcnt lgkmcnt(5)
    v_mfma_f32_16x16x32_bf16 v[20:23], v[140:143], v[184:187], v[20:23]
    ds_read_b64_tr_b16 v[202:203], v4 offset:45056
    s_waitcnt vmcnt(1)
    v_mfma_f32_16x16x32_bf16 v[24:27], v[144:147], v[184:187], v[24:27]
    ds_read_b64_tr_b16 v[204:205], v5 offset:8192
    v_mfma_f32_16x16x32_bf16 v[28:31], v[148:151], v[188:191], v[28:31]
    ds_read_b64_tr_b16 v[206:207], v5 offset:12288
    v_mfma_f32_16x16x32_bf16 v[32:35], v[152:155], v[188:191], v[32:35]
    ds_read_b64_tr_b16 v[180:181], v5 offset:40960
    s_waitcnt lgkmcnt(5)
    v_mfma_f32_16x16x32_bf16 v[28:31], v[156:159], v[192:195], v[28:31]
    ds_read_b64_tr_b16 v[182:183], v5 offset:45056
    v_mfma_f32_16x16x32_bf16 v[32:35], v[160:163], v[192:195], v[32:35]
    ds_read_b64_tr_b16 v[184:185], v2 offset:33024
    v_cvt_pk_bf16_f32 v172, v20, v21
    v_mfma_f32_16x16x32_bf16 v[28:31], v[116:119], v[196:199], v[28:31]
    ds_read_b64_tr_b16 v[186:187], v2 offset:37120
    v_cvt_pk_bf16_f32 v173, v22, v23
    v_mfma_f32_16x16x32_bf16 v[32:35], v[120:123], v[196:199], v[32:35]
    ds_read_b64_tr_b16 v[188:189], v3 offset:256
    ds_write_b64 v16, v[172:173] offset:0
    s_waitcnt lgkmcnt(6)
    v_cvt_pk_bf16_f32 v174, v24, v25
    v_mfma_f32_16x16x32_bf16 v[28:31], v[124:127], v[200:203], v[28:31]
    ds_read_b64_tr_b16 v[190:191], v3 offset:4352
    v_cvt_pk_bf16_f32 v175, v26, v27
    v_mfma_f32_16x16x32_bf16 v[32:35], v[128:131], v[200:203], v[32:35]
    ds_read_b64_tr_b16 v[192:193], v3 offset:33024
    ds_write_b64 v16, v[174:175] offset:32
    v_mfma_f32_16x16x32_bf16 v[28:31], v[132:135], v[204:207], v[28:31]
    ds_read_b64_tr_b16 v[194:195], v3 offset:37120
    ds_read_b128 v[20:23], v17 offset:0
    v_mfma_f32_16x16x32_bf16 v[32:35], v[136:139], v[204:207], v[32:35]
    ds_read_b64_tr_b16 v[196:197], v2 offset:41216
    s_waitcnt lgkmcnt(8)
    v_mfma_f32_16x16x32_bf16 v[28:31], v[140:143], v[180:183], v[28:31]
    ds_read_b64_tr_b16 v[198:199], v2 offset:45312
    v_mfma_f32_16x16x32_bf16 v[32:35], v[144:147], v[180:183], v[32:35]
    ds_read_b64_tr_b16 v[200:201], v3 offset:8448
    v_mfma_f32_16x16x32_bf16 v[36:39], v[148:151], v[184:187], v[36:39]
    ds_read_b64_tr_b16 v[202:203], v3 offset:12544
    v_mfma_f32_16x16x32_bf16 v[40:43], v[152:155], v[184:187], v[40:43]
    ds_read_b64_tr_b16 v[204:205], v3 offset:41216
    s_waitcnt lgkmcnt(6)
    v_mfma_f32_16x16x32_bf16 v[36:39], v[156:159], v[188:191], v[36:39]
    ds_read_b64_tr_b16 v[206:207], v3 offset:45312
    s_waitcnt lgkmcnt(6)
    buffer_store_dwordx4 v[20:23], v18, s[32:35], s40 offen nt
    s_add_u32 s40, s40, 0x20000
    v_mfma_f32_16x16x32_bf16 v[40:43], v[160:163], v[188:191], v[40:43]
    ds_read_b64_tr_b16 v[180:181], v4 offset:33024
    v_cvt_pk_bf16_f32 v176, v28, v29
    v_mfma_f32_16x16x32_bf16 v[36:39], v[116:119], v[192:195], v[36:39]
    ds_read_b64_tr_b16 v[182:183], v4 offset:37120
    v_cvt_pk_bf16_f32 v177, v30, v31
    v_mfma_f32_16x16x32_bf16 v[40:43], v[120:123], v[192:195], v[40:43]
    ds_read_b64_tr_b16 v[184:185], v5 offset:256
    ds_write_b64 v16, v[176:177] offset:1280
    s_waitcnt lgkmcnt(6)
    v_cvt_pk_bf16_f32 v178, v32, v33
    v_mfma_f32_16x16x32_bf16 v[36:39], v[124:127], v[196:199], v[36:39]
    ds_read_b64_tr_b16 v[186:187], v5 offset:4352
    v_cvt_pk_bf16_f32 v179, v34, v35
    v_mfma_f32_16x16x32_bf16 v[40:43], v[128:131], v[196:199], v[40:43]
    ds_read_b64_tr_b16 v[188:189], v5 offset:33024
    ds_write_b64 v16, v[178:179] offset:1312
    v_mfma_f32_16x16x32_bf16 v[36:39], v[132:135], v[200:203], v[36:39]
    ds_read_b64_tr_b16 v[190:191], v5 offset:37120
    ds_read_b128 v[28:31], v17 offset:1280
    v_mfma_f32_16x16x32_bf16 v[40:43], v[136:139], v[200:203], v[40:43]
    ds_read_b64_tr_b16 v[192:193], v4 offset:41216
    s_waitcnt lgkmcnt(8)
    v_mfma_f32_16x16x32_bf16 v[36:39], v[140:143], v[204:207], v[36:39]
    ds_read_b64_tr_b16 v[194:195], v4 offset:45312
    v_mfma_f32_16x16x32_bf16 v[40:43], v[144:147], v[204:207], v[40:43]
    ds_read_b64_tr_b16 v[196:197], v5 offset:8448
    v_mfma_f32_16x16x32_bf16 v[44:47], v[148:151], v[180:183], v[44:47]
    ds_read_b64_tr_b16 v[198:199], v5 offset:12544
    v_mfma_f32_16x16x32_bf16 v[48:51], v[152:155], v[180:183], v[48:51]
    ds_read_b64_tr_b16 v[200:201], v5 offset:41216
    s_waitcnt lgkmcnt(6)
    v_mfma_f32_16x16x32_bf16 v[44:47], v[156:159], v[184:187], v[44:47]
    ds_read_b64_tr_b16 v[202:203], v5 offset:45312
    s_waitcnt lgkmcnt(6)
    buffer_store_dwordx4 v[28:31], v18, s[32:35], s40 offen nt
    s_add_u32 s40, s40, 0x20000
    v_mfma_f32_16x16x32_bf16 v[48:51], v[160:163], v[184:187], v[48:51]
    ds_read_b64_tr_b16 v[204:205], v2 offset:33280
    v_cvt_pk_bf16_f32 v172, v36, v37
    v_mfma_f32_16x16x32_bf16 v[44:47], v[116:119], v[188:191], v[44:47]
    ds_read_b64_tr_b16 v[206:207], v2 offset:37376
    v_cvt_pk_bf16_f32 v173, v38, v39
    v_mfma_f32_16x16x32_bf16 v[48:51], v[120:123], v[188:191], v[48:51]
    ds_read_b64_tr_b16 v[180:181], v3 offset:512
    ds_write_b64 v16, v[172:173] offset:2560
    s_waitcnt lgkmcnt(6)
    v_cvt_pk_bf16_f32 v174, v40, v41
    v_mfma_f32_16x16x32_bf16 v[44:47], v[124:127], v[192:195], v[44:47]
    ds_read_b64_tr_b16 v[182:183], v3 offset:4608
    v_cvt_pk_bf16_f32 v175, v42, v43
    v_mfma_f32_16x16x32_bf16 v[48:51], v[128:131], v[192:195], v[48:51]
    ds_read_b64_tr_b16 v[184:185], v3 offset:33280
    ds_write_b64 v16, v[174:175] offset:2592
    v_mfma_f32_16x16x32_bf16 v[44:47], v[132:135], v[196:199], v[44:47]
    ds_read_b64_tr_b16 v[186:187], v3 offset:37376
    ds_read_b128 v[36:39], v17 offset:2560
    v_mfma_f32_16x16x32_bf16 v[48:51], v[136:139], v[196:199], v[48:51]
    ds_read_b64_tr_b16 v[188:189], v2 offset:41472
    s_waitcnt lgkmcnt(8)
    v_mfma_f32_16x16x32_bf16 v[44:47], v[140:143], v[200:203], v[44:47]
    ds_read_b64_tr_b16 v[190:191], v2 offset:45568
    v_mfma_f32_16x16x32_bf16 v[48:51], v[144:147], v[200:203], v[48:51]
    ds_read_b64_tr_b16 v[192:193], v3 offset:8704
    v_mfma_f32_16x16x32_bf16 v[52:55], v[148:151], v[204:207], v[52:55]
    ds_read_b64_tr_b16 v[194:195], v3 offset:12800
    v_mfma_f32_16x16x32_bf16 v[56:59], v[152:155], v[204:207], v[56:59]
    ds_read_b64_tr_b16 v[196:197], v3 offset:41472
    s_waitcnt lgkmcnt(6)
    v_mfma_f32_16x16x32_bf16 v[52:55], v[156:159], v[180:183], v[52:55]
    ds_read_b64_tr_b16 v[198:199], v3 offset:45568
    s_waitcnt lgkmcnt(6)
    buffer_store_dwordx4 v[36:39], v18, s[32:35], s40 offen nt
    s_add_u32 s40, s40, 0x20000
    v_mfma_f32_16x16x32_bf16 v[56:59], v[160:163], v[180:183], v[56:59]
    ds_read_b64_tr_b16 v[200:201], v4 offset:33280
    v_cvt_pk_bf16_f32 v176, v44, v45
    v_mfma_f32_16x16x32_bf16 v[52:55], v[116:119], v[184:187], v[52:55]
    ds_read_b64_tr_b16 v[202:203], v4 offset:37376
    v_cvt_pk_bf16_f32 v177, v46, v47
    v_mfma_f32_16x16x32_bf16 v[56:59], v[120:123], v[184:187], v[56:59]
    ds_read_b64_tr_b16 v[204:205], v5 offset:512
    ds_write_b64 v16, v[176:177] offset:3840
    s_waitcnt lgkmcnt(6)
    v_cvt_pk_bf16_f32 v178, v48, v49
    v_mfma_f32_16x16x32_bf16 v[52:55], v[124:127], v[188:191], v[52:55]
    ds_read_b64_tr_b16 v[206:207], v5 offset:4608
    v_cvt_pk_bf16_f32 v179, v50, v51
    v_mfma_f32_16x16x32_bf16 v[56:59], v[128:131], v[188:191], v[56:59]
    ds_read_b64_tr_b16 v[180:181], v5 offset:33280
    ds_write_b64 v16, v[178:179] offset:3872
    v_mfma_f32_16x16x32_bf16 v[52:55], v[132:135], v[192:195], v[52:55]
    ds_read_b64_tr_b16 v[182:183], v5 offset:37376
    ds_read_b128 v[44:47], v17 offset:3840
    v_mfma_f32_16x16x32_bf16 v[56:59], v[136:139], v[192:195], v[56:59]
    ds_read_b64_tr_b16 v[184:185], v4 offset:41472
    s_waitcnt lgkmcnt(8)
    v_mfma_f32_16x16x32_bf16 v[52:55], v[140:143], v[196:199], v[52:55]
    ds_read_b64_tr_b16 v[186:187], v4 offset:45568
    v_mfma_f32_16x16x32_bf16 v[56:59], v[144:147], v[196:199], v[56:59]
    ds_read_b64_tr_b16 v[188:189], v5 offset:8704
    v_mfma_f32_16x16x32_bf16 v[60:63], v[148:151], v[200:203], v[60:63]
    ds_read_b64_tr_b16 v[190:191], v5 offset:12800
    v_mfma_f32_16x16x32_bf16 v[64:67], v[152:155], v[200:203], v[64:67]
    ds_read_b64_tr_b16 v[192:193], v5 offset:41472
    s_waitcnt lgkmcnt(6)
    v_mfma_f32_16x16x32_bf16 v[60:63], v[156:159], v[204:207], v[60:63]
    ds_read_b64_tr_b16 v[194:195], v5 offset:45568
    s_waitcnt lgkmcnt(6)
    buffer_store_dwordx4 v[44:47], v18, s[32:35], s40 offen nt
    s_add_u32 s40, s40, 0x20000
    v_mfma_f32_16x16x32_bf16 v[64:67], v[160:163], v[204:207], v[64:67]
    ds_read_b64_tr_b16 v[196:197], v2 offset:33536
    v_cvt_pk_bf16_f32 v172, v52, v53
    v_mfma_f32_16x16x32_bf16 v[60:63], v[116:119], v[180:183], v[60:63]
    ds_read_b64_tr_b16 v[198:199], v2 offset:37632
    v_cvt_pk_bf16_f32 v173, v54, v55
    v_mfma_f32_16x16x32_bf16 v[64:67], v[120:123], v[180:183], v[64:67]
    ds_read_b64_tr_b16 v[200:201], v3 offset:768
    ds_write_b64 v16, v[172:173] offset:0
    s_waitcnt lgkmcnt(6)
    v_cvt_pk_bf16_f32 v174, v56, v57
    v_mfma_f32_16x16x32_bf16 v[60:63], v[124:127], v[184:187], v[60:63]
    ds_read_b64_tr_b16 v[202:203], v3 offset:4864
    v_cvt_pk_bf16_f32 v175, v58, v59
    v_mfma_f32_16x16x32_bf16 v[64:67], v[128:131], v[184:187], v[64:67]
    ds_read_b64_tr_b16 v[204:205], v3 offset:33536
    ds_write_b64 v16, v[174:175] offset:32
    v_mfma_f32_16x16x32_bf16 v[60:63], v[132:135], v[188:191], v[60:63]
    ds_read_b64_tr_b16 v[206:207], v3 offset:37632
    ds_read_b128 v[52:55], v17 offset:0
    v_mfma_f32_16x16x32_bf16 v[64:67], v[136:139], v[188:191], v[64:67]
    ds_read_b64_tr_b16 v[180:181], v2 offset:41728
    s_waitcnt lgkmcnt(8)
    v_mfma_f32_16x16x32_bf16 v[60:63], v[140:143], v[192:195], v[60:63]
    ds_read_b64_tr_b16 v[182:183], v2 offset:45824
    v_mfma_f32_16x16x32_bf16 v[64:67], v[144:147], v[192:195], v[64:67]
    ds_read_b64_tr_b16 v[184:185], v3 offset:8960
    v_mfma_f32_16x16x32_bf16 v[68:71], v[148:151], v[196:199], v[68:71]
    ds_read_b64_tr_b16 v[186:187], v3 offset:13056
    v_mfma_f32_16x16x32_bf16 v[72:75], v[152:155], v[196:199], v[72:75]
    ds_read_b64_tr_b16 v[188:189], v3 offset:41728
    s_waitcnt lgkmcnt(6)
    v_mfma_f32_16x16x32_bf16 v[68:71], v[156:159], v[200:203], v[68:71]
    ds_read_b64_tr_b16 v[190:191], v3 offset:45824
    s_waitcnt lgkmcnt(6)
    buffer_store_dwordx4 v[52:55], v18, s[32:35], s40 offen nt
    s_add_u32 s40, s40, 0x20000
    v_mfma_f32_16x16x32_bf16 v[72:75], v[160:163], v[200:203], v[72:75]
    ds_read_b64_tr_b16 v[192:193], v4 offset:33536
    v_cvt_pk_bf16_f32 v176, v60, v61
    v_mfma_f32_16x16x32_bf16 v[68:71], v[116:119], v[204:207], v[68:71]
    ds_read_b64_tr_b16 v[194:195], v4 offset:37632
    v_cvt_pk_bf16_f32 v177, v62, v63
    v_mfma_f32_16x16x32_bf16 v[72:75], v[120:123], v[204:207], v[72:75]
    ds_read_b64_tr_b16 v[196:197], v5 offset:768
    ds_write_b64 v16, v[176:177] offset:1280
    s_waitcnt lgkmcnt(6)
    v_cvt_pk_bf16_f32 v178, v64, v65
    v_mfma_f32_16x16x32_bf16 v[68:71], v[124:127], v[180:183], v[68:71]
    ds_read_b64_tr_b16 v[198:199], v5 offset:4864
    v_cvt_pk_bf16_f32 v179, v66, v67
    v_mfma_f32_16x16x32_bf16 v[72:75], v[128:131], v[180:183], v[72:75]
    ds_read_b64_tr_b16 v[200:201], v5 offset:33536
    ds_write_b64 v16, v[178:179] offset:1312
    v_mfma_f32_16x16x32_bf16 v[68:71], v[132:135], v[184:187], v[68:71]
    ds_read_b64_tr_b16 v[202:203], v5 offset:37632
    ds_read_b128 v[60:63], v17 offset:1280
    v_mfma_f32_16x16x32_bf16 v[72:75], v[136:139], v[184:187], v[72:75]
    ds_read_b64_tr_b16 v[204:205], v4 offset:41728
    s_waitcnt lgkmcnt(8)
    v_mfma_f32_16x16x32_bf16 v[68:71], v[140:143], v[188:191], v[68:71]
    ds_read_b64_tr_b16 v[206:207], v4 offset:45824
    v_mfma_f32_16x16x32_bf16 v[72:75], v[144:147], v[188:191], v[72:75]
    ds_read_b64_tr_b16 v[180:181], v5 offset:8960
    v_mfma_f32_16x16x32_bf16 v[76:79], v[148:151], v[192:195], v[76:79]
    ds_read_b64_tr_b16 v[182:183], v5 offset:13056
    v_mfma_f32_16x16x32_bf16 v[80:83], v[152:155], v[192:195], v[80:83]
    ds_read_b64_tr_b16 v[184:185], v5 offset:41728
    s_waitcnt lgkmcnt(6)
    v_mfma_f32_16x16x32_bf16 v[76:79], v[156:159], v[196:199], v[76:79]
    ds_read_b64_tr_b16 v[186:187], v5 offset:45824
    s_waitcnt lgkmcnt(6)
    buffer_store_dwordx4 v[60:63], v18, s[32:35], s40 offen nt
    s_add_u32 s40, s40, 0x20000
    v_mfma_f32_16x16x32_bf16 v[80:83], v[160:163], v[196:199], v[80:83]
    v_cvt_pk_bf16_f32 v172, v68, v69
    v_mfma_f32_16x16x32_bf16 v[76:79], v[116:119], v[200:203], v[76:79]
    v_cvt_pk_bf16_f32 v173, v70, v71
    v_mfma_f32_16x16x32_bf16 v[80:83], v[120:123], v[200:203], v[80:83]
    ds_write_b64 v16, v[172:173] offset:2560
    s_waitcnt lgkmcnt(3)
    v_cvt_pk_bf16_f32 v174, v72, v73
    v_mfma_f32_16x16x32_bf16 v[76:79], v[124:127], v[204:207], v[76:79]
    v_cvt_pk_bf16_f32 v175, v74, v75
    v_mfma_f32_16x16x32_bf16 v[80:83], v[128:131], v[204:207], v[80:83]
    ds_write_b64 v16, v[174:175] offset:2592
    v_mfma_f32_16x16x32_bf16 v[76:79], v[132:135], v[180:183], v[76:79]
    ds_read_b128 v[68:71], v17 offset:2560
    v_mfma_f32_16x16x32_bf16 v[80:83], v[136:139], v[180:183], v[80:83]
    s_waitcnt lgkmcnt(3)
    v_mfma_f32_16x16x32_bf16 v[76:79], v[140:143], v[184:187], v[76:79]
    v_mfma_f32_16x16x32_bf16 v[80:83], v[144:147], v[184:187], v[80:83]
    s_nop 6
    s_waitcnt lgkmcnt(0)
    buffer_store_dwordx4 v[68:71], v18, s[32:35], s40 offen nt
    s_add_u32 s40, s40, 0x20000
    v_cvt_pk_bf16_f32 v176, v76, v77
    v_cvt_pk_bf16_f32 v177, v78, v79
    ds_write_b64 v16, v[176:177] offset:3840
    v_cvt_pk_bf16_f32 v178, v80, v81
    v_cvt_pk_bf16_f32 v179, v82, v83
    ds_write_b64 v16, v[178:179] offset:3872
    ds_read_b128 v[76:79], v17 offset:3840
    s_waitcnt lgkmcnt(0)
    buffer_store_dwordx4 v[76:79], v18, s[32:35], s40 offen nt
    s_endpgm
L_ann_wait:
    s_mov_b32 s62, 0
    s_sub_u32 s63, s63, s65
    s_sub_u32 s64, s64, s65
L_ann_l:
    buffer_load_dwordx2 v[110:111], v112, s[28:31], s20 offen offset:128 sc1
    s_add_u32 s62, s62, 1
    s_waitcnt vmcnt(0)
    v_subrev_u32 v110, s63, v110
    v_subrev_u32 v111, s64, v111
    v_cmp_ne_u32 vcc, v110, v111
    v_cmp_le_u32 s[52:53], 16, v110
    s_cmp_ge_u32 s62, 0x1000000
    s_cbranch_scc1 L_ann_ok
    s_or_b64 vcc, vcc, s[52:53]
    s_cbranch_scc1 L_ann_l
    v_cmp_ne_u32 vcc, s65, v110
    s_nop 1
    s_cmp_lg_u64 vcc, 0
    s_cbranch_scc0 L_ann_ok
    s_mov_b32 s66, 1
    v_mov_b32 v170, v12
    v_mov_b32 v12, 2.0
    s_branch L_ann_ok
L_slow:
    v_mov_b32 v15, 4
    s_waitcnt vmcnt(0) lgkmcnt(0)
    buffer_store_dword v15, v170, s[28:31], 0 offen offset:256 sc1
    s_waitcnt vmcnt(0)
    s_branch L_slow_done
L_spin0:
    s_mov_b32 s62, 0
L_spin0_l:
    ds_read_b32 v14, v19
    s_add_u32 s62, s62, 1
    s_waitcnt lgkmcnt(0)
    v_readfirstlane_b32 s45, v14
    s_cmp_ge_u32 s62, 0x4000000
    s_cbranch_scc1 L_back0
    s_cmp_ge_u32 s45, 2
    s_cbranch_scc0 L_spin0_l
    s_branch L_back0
L_spinW:
    s_mov_b32 s62, 0
L_spinW_l:
    ds_read_b128 v[176:179], v19 offset:16
    s_add_u32 s62, s62, 1
    s_waitcnt lgkmcnt(0)
    v_min3_u32 v14, v176, v177, v178
    v_min_u32 v14, v14, v179
    s_nop 0
    v_readfirstlane_b32 s45, v14
    s_cmp_ge_u32 s62, 0x4000000
    s_cbranch_scc1 L_backW
    s_cmp_ge_u32 s45, 1
    s_cbranch_scc0 L_spinW_l
    s_branch L_backW
L_spin2:
    s_mov_b32 s62, 0
L_spin2_l:
    ds_read_b32 v14, v19
    s_add_u32 s62, s62, 1
    s_waitcnt lgkmcnt(0)
    v_readfirstlane_b32 s45, v14
    s_cmp_ge_u32 s62, 0x4000000
    s_cbranch_scc1 L_back2
    s_cmp_ge_u32 s45, 4
    s_cbranch_scc0 L_spin2_l
    s_branch L_back2
L_end:
.section .rodata,"a"
.p2align 6
.amdhsa_kernel standalone__edm_precond__diffusion_kernel
  .amdhsa_next_free_vgpr 256
  .amdhsa_next_free_sgpr 102
  .amdhsa_accum_offset 256
  .amdhsa_group_segment_fixed_size 0
  .amdhsa_kernarg_size 64
  .amdhsa_user_sgpr_count 2
  .amdhsa_user_sgpr_kernarg_segment_ptr 1
  .amdhsa_system_sgpr_workgroup_id_x 1
.end_amdhsa_kernel
```
